```python
import torch

def _softmax(x, axis=-1):
    return torch.softmax(x, dim=axis)
def _gelu(x):
    return torch.nn.functional.gelu(x, approximate="tanh")
def _silu(x):
    return torch.nn.functional.silu(x)
def _sigmoid(x):
    return torch.sigmoid(x)
def _layernorm(x, axis=-1, eps=1e-5):
    m = x.mean(dim=axis, keepdim=True)
    v = x.var(dim=axis, keepdim=True, unbiased=False)
    return (x - m) / torch.sqrt(v + eps)
def _scatter_add(tgt, idx, src, axis=0):
    return tgt.clone().index_add_(axis, idx, src)
def _segment_sum(src, seg, n):
    out = torch.zeros((n,) + src.shape[1:], dtype=src.dtype)
    return out.index_add_(0, seg, src)
def _pad(x, pw):
    flat = tuple(v for pair in reversed(pw) for v in pair)
    return torch.nn.functional.pad(x, flat)

kernel_name = 'standalone__mha_block_cached__near_ridge'

def setup_inputs():

    _w = (lambda a: (lambda t: t.to(torch.bfloat16) if t.is_floating_point() else t)(torch.as_tensor(a)))
    B, Sq, D = 8, 160, 1024
    H, Sk, Dh = 32, 512, 128
    return {
        "x": _w((lambda *s: torch.randn(*s, dtype=torch.bfloat16) * 0.8)(B, Sq, D)),
        "k_cache": _w((lambda *s: torch.randn(*s, dtype=torch.bfloat16) * 0.8)(B, H, Sk, Dh)),
        "v_cache": _w((lambda *s: torch.randn(*s, dtype=torch.bfloat16) * 0.05)(B, H, Sk, Dh)),
        "wq": _w((lambda *s: torch.randn(*s, dtype=torch.bfloat16) * 0.8)(D, H * Dh) * (D ** -0.5)),
        "wo": _w((lambda *s: torch.randn(*s, dtype=torch.bfloat16) * 0.05)(H * Dh, D) * ((H * Dh) ** -0.5)),
    }

def reference(x, k_cache, v_cache, wq, wo):
    B, Sq, D = x.shape
    H, Dh = 32, 128
    q = (lambda x, *d: x.permute(*d))((x @ wq).reshape(B, Sq, H, Dh), 0, 2, 1, 3)
    scores = torch.einsum("bhqd,bhkd->bhqk", q, k_cache) * (Dh ** -0.5)
    p = _softmax(scores, axis=-1)
    o = torch.einsum("bhqk,bhkd->bhqd", p, v_cache)
    return (lambda x, *d: x.permute(*d))(o, 0, 2, 1, 3).reshape(B, Sq, H * Dh) @ wo
```

```asm
; @launch grid=(256,1,1) block=(512,1,1) lds=163840
.amdgcn_target "amdgcn-amd-amdhsa--gfx950"
.text
.globl standalone__mha_block_cached__near_ridge_kernel
.p2align 8
.type standalone__mha_block_cached__near_ridge_kernel,@function
standalone__mha_block_cached__near_ridge_kernel:
F_begin:
    s_cmp_ge_u32 s2, 256
    s_cbranch_scc1 F_end
    s_load_dwordx8 s[36:43], s[0:1], 0
    s_load_dwordx2 s[44:45], s[0:1], 32
    s_load_dwordx4 s[48:51], s[0:1], 48
    v_lshrrev_b32 v2, 6, v0
    v_and_b32 v1, 63, v0
    v_readfirstlane_b32 s28, v2
    s_and_b32 s3, s2, 7
    s_lshr_b32 s4, s2, 3
    s_and_b32 s6, s4, 3
    s_lshr_b32 s7, s4, 2
    s_and_b32 s5, s3, 1
    s_lshl_b32 s29, s5, 2
    s_add_u32 s29, s29, s6
    s_mov_b32 s52, s7
    s_lshr_b32 s54, s3, 1
    s_lshl_b32 s30, s54, 3
    s_add_u32 s30, s30, s7
    s_lshl_b32 s53, s6, 1
    s_add_u32 s53, s53, s7
    s_add_u32 s53, s53, 1
    s_and_b32 s53, s53, 7
    s_add_u32 s6, s6, s7
    s_and_b32 s7, s6, 3
    v_lshrrev_b32 v2, 4, v1
    v_and_b32 v3, 15, v1
    v_bfe_u32 v4, v1, 2, 2
    v_and_b32 v5, 3, v1
    s_mov_b32 s32, 0x46800000
    s_cmp_ge_u32 s28, 4
    s_cbranch_scc0 F_main
F_helper:
    s_sub_u32 s31, s28, 4
    s_mov_b32 s4, 1702113808
    s_mov_b32 s5, 3992758712
    s_cmp_eq_u32 s7, 1
    s_cmov_b32 s4, 2018783760
    s_cmov_b32 s5, 4275809430
    s_cmp_eq_u32 s7, 2
    s_cmov_b32 s4, 2522100240
    s_cmov_b32 s5, 4274772615
    s_cmp_eq_u32 s7, 3
    s_cmov_b32 s4, 1985229328
    s_cmov_b32 s5, 4258183562
    s_and_b32 s33, s31, 1
    s_lshl_b32 s33, s33, 2
    v_and_b32 v6, 7, v1
    v_xor_b32 v6, v6, v2
    v_xor_b32 v6, s33, v6
    v_lshlrev_b32 v6, 4, v6
    v_lshrrev_b32 v7, 3, v1
    v_lshl_add_u32 v8, v7, 11, v6
    s_mul_i32 s47, s29, 327680
    s_lshl_b32 s33, s31, 14
    s_add_u32 s47, s47, s33
    s_lshr_b32 s33, s31, 1
    s_lshl_b32 s33, s33, 3
    v_lshlrev_b32 v6, 1, v2
    v_xor_b32 v6, v6, v3
    v_xor_b32 v6, s33, v6
    v_lshlrev_b32 v6, 4, v6
    v_lshl_add_u32 v9, v2, 13, v6
    s_lshl_b32 s35, s30, 8
    s_lshl_b32 s33, s31, 15
    s_add_u32 s35, s35, s33
    s_lshl_b32 s34, s31, 10
    s_waitcnt lgkmcnt(0)
    s_mov_b32 s8, s36
    s_mov_b32 s9, s37
    s_mov_b32 s10, 2621440
    s_mov_b32 s11, 0x20000
    s_mov_b32 s20, s42
    s_mov_b32 s21, s43
    s_mov_b32 s22, 8388608
    s_mov_b32 s23, 0x20000
    s_mov_b32 s12, s38
    s_mov_b32 s13, s39
    s_mov_b32 s14, 33554432
    s_mov_b32 s15, 0x20000
    s_mov_b32 s16, s40
    s_mov_b32 s17, s41
    s_mov_b32 s18, 33554432
    s_mov_b32 s19, 0x20000
    s_mov_b32 s56, s44
    s_mov_b32 s57, s45
    s_mov_b32 s58, 8388608
    s_mov_b32 s59, 0x20000
    s_mov_b32 s60, s48
    s_mov_b32 s61, s49
    s_mov_b32 s62, 256
    s_mov_b32 s63, 0x20000
    s_mov_b32 s24, s50
    s_mov_b32 s25, s51
    s_mov_b32 s26, 28311552
    s_mov_b32 s27, 0x20000
    s_mov_b32 s48, s35
    s_cmp_lg_u32 s31, 0
    s_cbranch_scc1 F_m1
    s_lshl_b32 s42, s29, 2
    s_add_u32 s42, s42, s54
    s_lshl_b32 s42, s42, 10
    s_add_u32 s42, s42, 16777216
    s_lshl_b32 s37, s52, 7
    s_add_u32 s42, s42, s37
    s_lshl_b32 s43, s29, 3
    s_add_u32 s43, s43, s53
    s_lshl_b32 s43, s43, 11
    s_add_u32 s43, s43, 16842752
    s_lshl_b32 s37, s54, 9
    s_add_u32 s43, s43, s37
    s_sub_u32 s43, s43, s42
    s_sub_u32 s43, s43, 128
    v_min_u32 v6, 1, v1
    v_mul_lo_u32 v7, s43, v6
    v_lshl_add_u32 v7, v1, 7, v7
    v_mov_b32 v6, 0
    s_mov_b64 exec, 31
    buffer_store_dword v6, v7, s[24:27], s42 offen sc1
    s_mov_b64 exec, -1
F_m1:
    s_bfe_u32 s42, s4, 262144
    s_lshl_b32 s43, s42, 7
    s_add_u32 s43, s43, s47
    s_lshl_b32 s44, s42, 19
    s_add_u32 s44, s44, s48
    s_add_u32 m0, s34, 69632
    s_add_u32 s37, s44, 0
    buffer_load_dwordx4 v9, s[20:23], s37 offen lds
    s_add_u32 m0, s34, 49152
    s_add_u32 s37, s43, 0
    buffer_load_dwordx4 v8, s[8:11], s37 offen lds
    s_add_u32 m0, s34, 53248
    s_add_u32 s37, s43, 65536
    buffer_load_dwordx4 v8, s[8:11], s37 offen lds
    s_add_u32 m0, s34, 73728
    s_add_u32 s37, s44, 131072
    buffer_load_dwordx4 v9, s[20:23], s37 offen lds
    s_add_u32 m0, s34, 57344
    s_add_u32 s37, s43, 131072
    buffer_load_dwordx4 v8, s[8:11], s37 offen lds
    s_add_u32 m0, s34, 77824
    s_add_u32 s37, s44, 262144
    buffer_load_dwordx4 v9, s[20:23], s37 offen lds
    s_add_u32 m0, s34, 61440
    s_add_u32 s37, s43, 196608
    buffer_load_dwordx4 v8, s[8:11], s37 offen lds
    s_add_u32 m0, s34, 81920
    s_add_u32 s37, s44, 393216
    buffer_load_dwordx4 v9, s[20:23], s37 offen lds
    s_add_u32 m0, s34, 65536
    s_add_u32 s37, s43, 262144
    buffer_load_dwordx4 v8, s[8:11], s37 offen lds
    s_lshr_b32 s6, s2, 3
    s_mul_i32 s6, s6, 3
    s_lshr_b32 s6, s6, 3
    s_add_u32 s6, s6, 1
    s_cmp_lg_u32 s31, 0
    s_cselect_b32 s51, 63, s6
    s_lshl_b32 s42, s31, 2
    v_xor_b32 v6, v3, v2
    v_xor_b32 v6, s42, v6
    v_lshlrev_b32 v6, 4, v6
    v_lshl_add_u32 v10, v2, 8, v6
    v_lshlrev_b32 v6, 2, v2
    v_xor_b32 v6, v6, v3
    v_lshlrev_b32 v6, 4, v6
    v_lshl_add_u32 v11, v2, 8, v6
    s_lshl_b32 s46, s29, 5
    s_add_u32 s46, s46, s30
    s_lshl_b32 s46, s46, 17
    s_add_u32 s46, s46, s34
    v_and_b32 v6, 31, v1
    v_lshlrev_b32 v6, 8, v6
    v_lshrrev_b32 v7, 5, v1
    v_xor_b32 v7, v7, v3
    v_lshl_add_u32 v6, v7, 4, v6
    v_xor_b32 v16, 0, v6
    v_xor_b32 v17, 32, v6
    v_xor_b32 v18, 64, v6
    v_xor_b32 v19, 96, v6
    v_xor_b32 v20, 128, v6
    v_xor_b32 v21, 160, v6
    v_xor_b32 v22, 192, v6
    v_xor_b32 v23, 224, v6
    v_lshrrev_b32 v6, 5, v1
    v_lshl_add_u32 v6, v6, 2, v4
    v_lshlrev_b32 v6, 8, v6
    v_lshl_add_u32 v6, v4, 6, v6
    v_and_b32 v7, 1, v2
    v_lshl_add_u32 v6, v7, 5, v6
    v_lshl_add_u32 v6, v5, 3, v6
    s_lshl_b32 s42, s31, 6
    v_xor_b32 v6, s42, v6
    v_xor_b32 v24, 0, v6
    v_xor_b32 v25, 64, v6
    v_xor_b32 v26, 128, v6
    v_xor_b32 v27, 192, v6
    v_mov_b32 v14, 0
    v_mov_b32 v96, 0
    v_mov_b32 v97, 0
    v_mov_b32 v98, 0
    v_mov_b32 v99, 0
    v_mov_b32 v100, 0
    v_mov_b32 v101, 0
    v_mov_b32 v102, 0
    v_mov_b32 v103, 0
    v_mov_b32 v104, 0
    v_mov_b32 v105, 0
    v_mov_b32 v106, 0
    v_mov_b32 v107, 0
    v_mov_b32 v108, 0
    v_mov_b32 v109, 0
    v_mov_b32 v110, 0
    v_mov_b32 v111, 0
    v_lshlrev_b32 v6, 4, v1
    v_add_u32 v12, s34, v6
    v_lshlrev_b32 v6, 1, v2
    v_xor_b32 v6, v6, v3
    v_lshlrev_b32 v6, 4, v6
    v_lshl_add_u32 v6, v2, 11, v6
    s_lshl_b32 s42, s31, 15
    s_lshl_b32 s43, s53, 8
    s_add_u32 s42, s42, s43
    v_add_u32 v13, s42, v6
    s_and_b32 s42, s31, 1
    s_lshl_b32 s42, s42, 13
    v_add_u32 v16, s42, v16
    v_add_u32 v17, s42, v17
    v_add_u32 v18, s42, v18
    v_add_u32 v19, s42, v19
    v_add_u32 v20, s42, v20
    v_add_u32 v21, s42, v21
    v_add_u32 v22, s42, v22
    v_add_u32 v23, s42, v23
    v_add_u32 v24, s42, v24
    v_add_u32 v25, s42, v25
    v_add_u32 v26, s42, v26
    v_add_u32 v27, s42, v27
    s_mov_b32 s35, 0
    s_mov_b32 s36, 0
    s_mul_i32 s50, s29, 5
    s_add_u32 s50, s50, 4
    s_mul_i32 s50, s50, 263168
    s_lshl_b32 s42, s30, 2
    s_add_u32 s42, s42, s31
    s_mul_i32 s42, s42, 2048
    s_add_u32 s50, s50, s42
    s_add_u32 s50, s50, 8192
    s_lshr_b32 s3, s2, 3
    s_mov_b32 s55, 1365721648
    s_cmp_eq_u32 s3, 1
    s_cmov_b32 s55, 359088688
    s_cmp_eq_u32 s3, 2
    s_cmov_b32 s55, 354641728
    s_cmp_eq_u32 s3, 3
    s_cmov_b32 s55, 1363293808
    s_cmp_eq_u32 s3, 4
    s_cmov_b32 s55, 1466184193
    s_cmp_eq_u32 s3, 5
    s_cmov_b32 s55, 1349927713
    s_cmp_eq_u32 s3, 6
    s_cmov_b32 s55, 1394636353
    s_cmp_eq_u32 s3, 7
    s_cmov_b32 s55, 1412564833
    s_cmp_eq_u32 s3, 8
    s_cmov_b32 s55, 1365721858
    s_cmp_eq_u32 s3, 9
    s_cmov_b32 s55, 352744498
    s_cmp_eq_u32 s3, 10
    s_cmov_b32 s55, 355493698
    s_cmp_eq_u32 s3, 11
    s_cmov_b32 s55, 1363347058
    s_cmp_eq_u32 s3, 12
    s_cmov_b32 s55, 1366704643
    s_cmp_eq_u32 s3, 13
    s_cmov_b32 s55, 352805923
    s_cmp_eq_u32 s3, 14
    s_cmov_b32 s55, 354448963
    s_cmp_eq_u32 s3, 15
    s_cmov_b32 s55, 1363281763
    s_cmp_eq_u32 s3, 16
    s_cmov_b32 s55, 1365713668
    s_cmp_eq_u32 s3, 17
    s_cmov_b32 s55, 352743988
    s_cmp_eq_u32 s3, 18
    s_cmov_b32 s55, 354616948
    s_cmp_eq_u32 s3, 19
    s_cmov_b32 s55, 1361249908
    s_cmp_eq_u32 s3, 20
    s_cmov_b32 s55, 392442373
    s_cmp_eq_u32 s3, 21
    s_cmov_b32 s55, 276185893
    s_cmp_eq_u32 s3, 22
    s_cmov_b32 s55, 320894533
    s_cmp_eq_u32 s3, 23
    s_cmov_b32 s55, 338823013
    s_cmp_eq_u32 s3, 24
    s_cmov_b32 s55, 1366565638
    s_cmp_eq_u32 s3, 25
    s_cmov_b32 s55, 352797238
    s_cmp_eq_u32 s3, 26
    s_cmov_b32 s55, 354617158
    s_cmp_eq_u32 s3, 27
    s_cmov_b32 s55, 1363292278
    s_cmp_eq_u32 s3, 28
    s_cmov_b32 s55, 1365520903
    s_cmp_eq_u32 s3, 29
    s_cmov_b32 s55, 352731943
    s_cmp_eq_u32 s3, 30
    s_cmov_b32 s55, 355599943
    s_cmp_eq_u32 s3, 31
    s_cmov_b32 s55, 1363353703
    s_bfe_u32 s42, s4, 262148
    s_lshl_b32 s43, s42, 7
    s_add_u32 s43, s43, s47
    s_lshl_b32 s44, s42, 19
    s_add_u32 s44, s44, s48
    s_add_u32 m0, s34, 106496
    s_add_u32 s37, s44, 0
    buffer_load_dwordx4 v9, s[20:23], s37 offen lds
    s_add_u32 m0, s34, 86016
    s_add_u32 s37, s43, 0
    buffer_load_dwordx4 v8, s[8:11], s37 offen lds
    s_add_u32 m0, s34, 90112
    s_add_u32 s37, s43, 65536
    buffer_load_dwordx4 v8, s[8:11], s37 offen lds
    s_add_u32 m0, s34, 110592
    s_add_u32 s37, s44, 131072
    buffer_load_dwordx4 v9, s[20:23], s37 offen lds
    s_add_u32 m0, s34, 94208
    s_add_u32 s37, s43, 131072
    buffer_load_dwordx4 v8, s[8:11], s37 offen lds
    s_add_u32 m0, s34, 114688
    s_add_u32 s37, s44, 262144
    buffer_load_dwordx4 v9, s[20:23], s37 offen lds
    s_add_u32 m0, s34, 98304
    s_add_u32 s37, s43, 196608
    buffer_load_dwordx4 v8, s[8:11], s37 offen lds
    s_add_u32 m0, s34, 118784
    s_add_u32 s37, s44, 393216
    buffer_load_dwordx4 v9, s[20:23], s37 offen lds
    s_add_u32 m0, s34, 102400
    s_add_u32 s37, s43, 262144
    buffer_load_dwordx4 v8, s[8:11], s37 offen lds
    s_waitcnt vmcnt(9)
    s_barrier
    s_bfe_u32 s42, s4, 262152
    s_lshl_b32 s43, s42, 7
    s_add_u32 s43, s43, s47
    s_lshl_b32 s44, s42, 19
    s_add_u32 s44, s44, s48
    s_add_u32 m0, s34, 143360
    s_add_u32 s37, s44, 0
    buffer_load_dwordx4 v9, s[20:23], s37 offen lds
    s_add_u32 m0, s34, 122880
    s_add_u32 s37, s43, 0
    buffer_load_dwordx4 v8, s[8:11], s37 offen lds
    s_add_u32 m0, s34, 126976
    s_add_u32 s37, s43, 65536
    buffer_load_dwordx4 v8, s[8:11], s37 offen lds
    s_add_u32 m0, s34, 147456
    s_add_u32 s37, s44, 131072
    buffer_load_dwordx4 v9, s[20:23], s37 offen lds
    s_add_u32 m0, s34, 131072
    s_add_u32 s37, s43, 131072
    buffer_load_dwordx4 v8, s[8:11], s37 offen lds
    s_add_u32 m0, s34, 151552
    s_add_u32 s37, s44, 262144
    buffer_load_dwordx4 v9, s[20:23], s37 offen lds
    s_add_u32 m0, s34, 135168
    s_add_u32 s37, s43, 196608
    buffer_load_dwordx4 v8, s[8:11], s37 offen lds
    s_add_u32 m0, s34, 155648
    s_add_u32 s37, s44, 393216
    buffer_load_dwordx4 v9, s[20:23], s37 offen lds
    s_add_u32 m0, s34, 139264
    s_add_u32 s37, s43, 262144
    buffer_load_dwordx4 v8, s[8:11], s37 offen lds
    s_cmp_eq_u32 s7, 0
    s_cbranch_scc0 F_nokv0_0
    s_add_u32 m0, s34, 0
    s_add_u32 s37, s46, 0
    buffer_load_dwordx4 v10, s[12:15], s37 offen nt lds
    s_add_u32 m0, s34, 4096
    s_add_u32 s37, s46, 4096
    buffer_load_dwordx4 v10, s[12:15], s37 offen nt lds
    s_add_u32 m0, s34, 8192
    s_add_u32 s37, s46, 8192
    buffer_load_dwordx4 v10, s[12:15], s37 offen nt lds
    s_add_u32 m0, s34, 12288
    s_add_u32 s37, s46, 12288
    buffer_load_dwordx4 v10, s[12:15], s37 offen nt lds
    s_add_u32 m0, s34, 16384
    s_add_u32 s37, s46, 16384
    buffer_load_dwordx4 v10, s[12:15], s37 offen nt lds
    s_add_u32 m0, s34, 20480
    s_add_u32 s37, s46, 20480
    buffer_load_dwordx4 v10, s[12:15], s37 offen nt lds
    s_add_u32 m0, s34, 24576
    s_add_u32 s37, s46, 24576
    buffer_load_dwordx4 v10, s[12:15], s37 offen nt lds
    s_add_u32 m0, s34, 28672
    s_add_u32 s37, s46, 28672
    buffer_load_dwordx4 v10, s[12:15], s37 offen nt lds
F_nokv0_0:
    s_cmp_eq_u32 s7, 1
    s_cbranch_scc0 F_nokv0_1
    s_add_u32 m0, s34, 0
    s_add_u32 s37, s46, 0
    buffer_load_dwordx4 v10, s[12:15], s37 offen nt lds
    s_add_u32 m0, s34, 4096
    s_add_u32 s37, s46, 4096
    buffer_load_dwordx4 v10, s[12:15], s37 offen nt lds
    s_add_u32 m0, s34, 8192
    s_add_u32 s37, s46, 8192
    buffer_load_dwordx4 v10, s[12:15], s37 offen nt lds
    s_add_u32 m0, s34, 12288
    s_add_u32 s37, s46, 12288
    buffer_load_dwordx4 v10, s[12:15], s37 offen nt lds
    s_add_u32 m0, s34, 16384
    s_add_u32 s37, s46, 16384
    buffer_load_dwordx4 v10, s[12:15], s37 offen nt lds
    s_add_u32 m0, s34, 20480
    s_add_u32 s37, s46, 20480
    buffer_load_dwordx4 v10, s[12:15], s37 offen nt lds
    s_add_u32 m0, s34, 24576
    s_add_u32 s37, s46, 24576
    buffer_load_dwordx4 v10, s[12:15], s37 offen nt lds
    s_add_u32 m0, s34, 28672
    s_add_u32 s37, s46, 28672
    buffer_load_dwordx4 v10, s[12:15], s37 offen nt lds
F_nokv0_1:
    s_cmp_eq_u32 s7, 0
    s_cbranch_scc1 F_w1_0
    s_cmp_eq_u32 s7, 1
    s_cbranch_scc1 F_w1_1
    s_waitcnt vmcnt(9)
    s_branch F_wd1
F_w1_0:
    s_waitcnt vmcnt(17)
    s_branch F_wd1
F_w1_1:
    s_waitcnt vmcnt(17)
F_wd1:
    s_barrier
    s_bfe_u32 s42, s4, 262156
    s_lshl_b32 s43, s42, 7
    s_add_u32 s43, s43, s47
    s_lshl_b32 s44, s42, 19
    s_add_u32 s44, s44, s48
    s_add_u32 m0, s34, 69632
    s_add_u32 s37, s44, 0
    buffer_load_dwordx4 v9, s[20:23], s37 offen lds
    s_add_u32 m0, s34, 49152
    s_add_u32 s37, s43, 0
    buffer_load_dwordx4 v8, s[8:11], s37 offen lds
    s_add_u32 m0, s34, 53248
    s_add_u32 s37, s43, 65536
    buffer_load_dwordx4 v8, s[8:11], s37 offen lds
    s_add_u32 m0, s34, 73728
    s_add_u32 s37, s44, 131072
    buffer_load_dwordx4 v9, s[20:23], s37 offen lds
    s_add_u32 m0, s34, 57344
    s_add_u32 s37, s43, 131072
    buffer_load_dwordx4 v8, s[8:11], s37 offen lds
    s_add_u32 m0, s34, 77824
    s_add_u32 s37, s44, 262144
    buffer_load_dwordx4 v9, s[20:23], s37 offen lds
    s_add_u32 m0, s34, 61440
    s_add_u32 s37, s43, 196608
    buffer_load_dwordx4 v8, s[8:11], s37 offen lds
    s_add_u32 m0, s34, 81920
    s_add_u32 s37, s44, 393216
    buffer_load_dwordx4 v9, s[20:23], s37 offen lds
    s_add_u32 m0, s34, 65536
    s_add_u32 s37, s43, 262144
    buffer_load_dwordx4 v8, s[8:11], s37 offen lds
    s_cmp_lg_u32 s51, 1
    s_cbranch_scc1 F_m3_1
    s_mov_b32 s6, 1
    s_atomic_add s6, s[60:61], 0x0 glc
F_m3_1:
    s_cmp_eq_u32 s7, 2
    s_cbranch_scc0 F_nokv1_2
    s_add_u32 m0, s34, 0
    s_add_u32 s37, s46, 0
    buffer_load_dwordx4 v10, s[12:15], s37 offen nt lds
    s_add_u32 m0, s34, 4096
    s_add_u32 s37, s46, 4096
    buffer_load_dwordx4 v10, s[12:15], s37 offen nt lds
    s_add_u32 m0, s34, 8192
    s_add_u32 s37, s46, 8192
    buffer_load_dwordx4 v10, s[12:15], s37 offen nt lds
    s_add_u32 m0, s34, 12288
    s_add_u32 s37, s46, 12288
    buffer_load_dwordx4 v10, s[12:15], s37 offen nt lds
    s_add_u32 m0, s34, 16384
    s_add_u32 s37, s46, 16384
    buffer_load_dwordx4 v10, s[12:15], s37 offen nt lds
    s_add_u32 m0, s34, 20480
    s_add_u32 s37, s46, 20480
    buffer_load_dwordx4 v10, s[12:15], s37 offen nt lds
    s_add_u32 m0, s34, 24576
    s_add_u32 s37, s46, 24576
    buffer_load_dwordx4 v10, s[12:15], s37 offen nt lds
    s_add_u32 m0, s34, 28672
    s_add_u32 s37, s46, 28672
    buffer_load_dwordx4 v10, s[12:15], s37 offen nt lds
F_nokv1_2:
    s_cmp_eq_u32 s7, 0
    s_cbranch_scc1 F_w2_0
    s_cmp_eq_u32 s7, 1
    s_cbranch_scc1 F_w2_1
    s_cmp_eq_u32 s7, 2
    s_cbranch_scc1 F_w2_2
    s_waitcnt vmcnt(9)
    s_branch F_wd2
F_w2_0:
    s_waitcnt vmcnt(17)
    s_branch F_wd2
F_w2_1:
    s_waitcnt vmcnt(17)
    s_branch F_wd2
F_w2_2:
    s_waitcnt vmcnt(17)
F_wd2:
    s_barrier
    s_bfe_u32 s42, s4, 262160
    s_lshl_b32 s43, s42, 7
    s_add_u32 s43, s43, s47
    s_lshl_b32 s44, s42, 19
    s_add_u32 s44, s44, s48
    s_add_u32 m0, s34, 106496
    s_add_u32 s37, s44, 0
    buffer_load_dwordx4 v9, s[20:23], s37 offen lds
    s_add_u32 m0, s34, 86016
    s_add_u32 s37, s43, 0
    buffer_load_dwordx4 v8, s[8:11], s37 offen lds
    s_add_u32 m0, s34, 90112
    s_add_u32 s37, s43, 65536
    buffer_load_dwordx4 v8, s[8:11], s37 offen lds
    s_add_u32 m0, s34, 110592
    s_add_u32 s37, s44, 131072
    buffer_load_dwordx4 v9, s[20:23], s37 offen lds
    s_add_u32 m0, s34, 94208
    s_add_u32 s37, s43, 131072
    buffer_load_dwordx4 v8, s[8:11], s37 offen lds
    s_add_u32 m0, s34, 114688
    s_add_u32 s37, s44, 262144
    buffer_load_dwordx4 v9, s[20:23], s37 offen lds
    s_add_u32 m0, s34, 98304
    s_add_u32 s37, s43, 196608
    buffer_load_dwordx4 v8, s[8:11], s37 offen lds
    s_add_u32 m0, s34, 118784
    s_add_u32 s37, s44, 393216
    buffer_load_dwordx4 v9, s[20:23], s37 offen lds
    s_add_u32 m0, s34, 102400
    s_add_u32 s37, s43, 262144
    buffer_load_dwordx4 v8, s[8:11], s37 offen lds
    s_cmp_lg_u32 s51, 2
    s_cbranch_scc1 F_m3_2
    s_mov_b32 s6, 1
    s_atomic_add s6, s[60:61], 0x0 glc
F_m3_2:
    s_cmp_eq_u32 s7, 3
    s_cbranch_scc0 F_nokv2_3
    s_add_u32 m0, s34, 0
    s_add_u32 s37, s46, 0
    buffer_load_dwordx4 v10, s[12:15], s37 offen nt lds
    s_add_u32 m0, s34, 4096
    s_add_u32 s37, s46, 4096
    buffer_load_dwordx4 v10, s[12:15], s37 offen nt lds
    s_add_u32 m0, s34, 8192
    s_add_u32 s37, s46, 8192
    buffer_load_dwordx4 v10, s[12:15], s37 offen nt lds
    s_add_u32 m0, s34, 12288
    s_add_u32 s37, s46, 12288
    buffer_load_dwordx4 v10, s[12:15], s37 offen nt lds
    s_add_u32 m0, s34, 16384
    s_add_u32 s37, s46, 16384
    buffer_load_dwordx4 v10, s[12:15], s37 offen nt lds
    s_add_u32 m0, s34, 20480
    s_add_u32 s37, s46, 20480
    buffer_load_dwordx4 v10, s[12:15], s37 offen nt lds
    s_add_u32 m0, s34, 24576
    s_add_u32 s37, s46, 24576
    buffer_load_dwordx4 v10, s[12:15], s37 offen nt lds
    s_add_u32 m0, s34, 28672
    s_add_u32 s37, s46, 28672
    buffer_load_dwordx4 v10, s[12:15], s37 offen nt lds
F_nokv2_3:
    s_cmp_eq_u32 s7, 2
    s_cbranch_scc1 F_w3_0
    s_cmp_eq_u32 s7, 3
    s_cbranch_scc1 F_w3_1
    s_waitcnt vmcnt(9)
    s_branch F_wd3
F_w3_0:
    s_waitcnt vmcnt(17)
    s_branch F_wd3
F_w3_1:
    s_waitcnt vmcnt(17)
F_wd3:
    s_barrier
    s_bfe_u32 s42, s4, 262164
    s_lshl_b32 s43, s42, 7
    s_add_u32 s43, s43, s47
    s_lshl_b32 s44, s42, 19
    s_add_u32 s44, s44, s48
    s_add_u32 m0, s34, 143360
    s_add_u32 s37, s44, 0
    buffer_load_dwordx4 v9, s[20:23], s37 offen lds
    s_add_u32 m0, s34, 122880
    s_add_u32 s37, s43, 0
    buffer_load_dwordx4 v8, s[8:11], s37 offen lds
    s_add_u32 m0, s34, 126976
    s_add_u32 s37, s43, 65536
    buffer_load_dwordx4 v8, s[8:11], s37 offen lds
    s_add_u32 m0, s34, 147456
    s_add_u32 s37, s44, 131072
    buffer_load_dwordx4 v9, s[20:23], s37 offen lds
    s_add_u32 m0, s34, 131072
    s_add_u32 s37, s43, 131072
    buffer_load_dwordx4 v8, s[8:11], s37 offen lds
    s_add_u32 m0, s34, 151552
    s_add_u32 s37, s44, 262144
    buffer_load_dwordx4 v9, s[20:23], s37 offen lds
    s_add_u32 m0, s34, 135168
    s_add_u32 s37, s43, 196608
    buffer_load_dwordx4 v8, s[8:11], s37 offen lds
    s_add_u32 m0, s34, 155648
    s_add_u32 s37, s44, 393216
    buffer_load_dwordx4 v9, s[20:23], s37 offen lds
    s_add_u32 m0, s34, 139264
    s_add_u32 s37, s43, 262144
    buffer_load_dwordx4 v8, s[8:11], s37 offen lds
    s_cmp_lg_u32 s51, 3
    s_cbranch_scc1 F_m3_3
    s_mov_b32 s6, 1
    s_atomic_add s6, s[60:61], 0x0 glc
F_m3_3:
    s_cmp_eq_u32 s7, 0
    s_cbranch_scc0 F_nokv3_0
    s_add_u32 m0, s34, 32768
    s_add_u32 s37, s46, 0
    buffer_load_dwordx4 v11, s[16:19], s37 offen nt lds
    s_add_u32 m0, s34, 36864
    s_add_u32 s37, s46, 4096
    buffer_load_dwordx4 v11, s[16:19], s37 offen nt lds
    s_add_u32 m0, s34, 40960
    s_add_u32 s37, s46, 8192
    buffer_load_dwordx4 v11, s[16:19], s37 offen nt lds
    s_add_u32 m0, s34, 45056
    s_add_u32 s37, s46, 12288
    buffer_load_dwordx4 v11, s[16:19], s37 offen nt lds
    s_add_u32 s37, s46, 32768
    buffer_load_dwordx4 v[80:83], v10, s[12:15], s37 offen nt
    s_add_u32 s37, s46, 36864
    buffer_load_dwordx4 v[84:87], v10, s[12:15], s37 offen nt
    s_add_u32 s37, s46, 40960
    buffer_load_dwordx4 v[88:91], v10, s[12:15], s37 offen nt
    s_add_u32 s37, s46, 45056
    buffer_load_dwordx4 v[92:95], v10, s[12:15], s37 offen nt
F_nokv3_0:
    s_cmp_eq_u32 s7, 0
    s_cbranch_scc1 F_w4_0
    s_cmp_eq_u32 s7, 3
    s_cbranch_scc1 F_w4_1
    s_waitcnt vmcnt(9)
    s_branch F_wd4
F_w4_0:
    s_waitcnt vmcnt(17)
    s_branch F_wd4
F_w4_1:
    s_waitcnt vmcnt(17)
F_wd4:
    s_barrier
    s_bfe_u32 s42, s4, 262168
    s_lshl_b32 s43, s42, 7
    s_add_u32 s43, s43, s47
    s_lshl_b32 s44, s42, 19
    s_add_u32 s44, s44, s48
    s_add_u32 m0, s34, 69632
    s_add_u32 s37, s44, 0
    buffer_load_dwordx4 v9, s[20:23], s37 offen lds
    s_add_u32 m0, s34, 49152
    s_add_u32 s37, s43, 0
    buffer_load_dwordx4 v8, s[8:11], s37 offen lds
    s_add_u32 m0, s34, 53248
    s_add_u32 s37, s43, 65536
    buffer_load_dwordx4 v8, s[8:11], s37 offen lds
    s_add_u32 m0, s34, 73728
    s_add_u32 s37, s44, 131072
    buffer_load_dwordx4 v9, s[20:23], s37 offen lds
    s_add_u32 m0, s34, 57344
    s_add_u32 s37, s43, 131072
    buffer_load_dwordx4 v8, s[8:11], s37 offen lds
    s_add_u32 m0, s34, 77824
    s_add_u32 s37, s44, 262144
    buffer_load_dwordx4 v9, s[20:23], s37 offen lds
    s_add_u32 m0, s34, 61440
    s_add_u32 s37, s43, 196608
    buffer_load_dwordx4 v8, s[8:11], s37 offen lds
    s_add_u32 m0, s34, 81920
    s_add_u32 s37, s44, 393216
    buffer_load_dwordx4 v9, s[20:23], s37 offen lds
    s_add_u32 m0, s34, 65536
    s_add_u32 s37, s43, 262144
    buffer_load_dwordx4 v8, s[8:11], s37 offen lds
    s_cmp_lg_u32 s51, 4
    s_cbranch_scc1 F_m3_4
    s_mov_b32 s6, 1
    s_atomic_add s6, s[60:61], 0x0 glc
F_m3_4:
    s_cmp_eq_u32 s7, 1
    s_cbranch_scc0 F_nokv4_1
    s_add_u32 m0, s34, 32768
    s_add_u32 s37, s46, 0
    buffer_load_dwordx4 v11, s[16:19], s37 offen nt lds
    s_add_u32 m0, s34, 36864
    s_add_u32 s37, s46, 4096
    buffer_load_dwordx4 v11, s[16:19], s37 offen nt lds
    s_add_u32 m0, s34, 40960
    s_add_u32 s37, s46, 8192
    buffer_load_dwordx4 v11, s[16:19], s37 offen nt lds
    s_add_u32 m0, s34, 45056
    s_add_u32 s37, s46, 12288
    buffer_load_dwordx4 v11, s[16:19], s37 offen nt lds
    s_add_u32 s37, s46, 32768
    buffer_load_dwordx4 v[80:83], v10, s[12:15], s37 offen nt
    s_add_u32 s37, s46, 36864
    buffer_load_dwordx4 v[84:87], v10, s[12:15], s37 offen nt
    s_add_u32 s37, s46, 40960
    buffer_load_dwordx4 v[88:91], v10, s[12:15], s37 offen nt
    s_add_u32 s37, s46, 45056
    buffer_load_dwordx4 v[92:95], v10, s[12:15], s37 offen nt
F_nokv4_1:
    s_cmp_eq_u32 s7, 0
    s_cbranch_scc1 F_w5_0
    s_cmp_eq_u32 s7, 1
    s_cbranch_scc1 F_w5_1
    s_waitcnt vmcnt(9)
    s_branch F_wd5
F_w5_0:
    s_waitcnt vmcnt(17)
    s_branch F_wd5
F_w5_1:
    s_waitcnt vmcnt(17)
F_wd5:
    s_barrier
    s_bfe_u32 s42, s4, 262172
    s_lshl_b32 s43, s42, 7
    s_add_u32 s43, s43, s47
    s_lshl_b32 s44, s42, 19
    s_add_u32 s44, s44, s48
    s_add_u32 m0, s34, 106496
    s_add_u32 s37, s44, 0
    buffer_load_dwordx4 v9, s[20:23], s37 offen lds
    s_add_u32 m0, s34, 86016
    s_add_u32 s37, s43, 0
    buffer_load_dwordx4 v8, s[8:11], s37 offen lds
    s_add_u32 m0, s34, 90112
    s_add_u32 s37, s43, 65536
    buffer_load_dwordx4 v8, s[8:11], s37 offen lds
    s_add_u32 m0, s34, 110592
    s_add_u32 s37, s44, 131072
    buffer_load_dwordx4 v9, s[20:23], s37 offen lds
    s_add_u32 m0, s34, 94208
    s_add_u32 s37, s43, 131072
    buffer_load_dwordx4 v8, s[8:11], s37 offen lds
    s_add_u32 m0, s34, 114688
    s_add_u32 s37, s44, 262144
    buffer_load_dwordx4 v9, s[20:23], s37 offen lds
    s_add_u32 m0, s34, 98304
    s_add_u32 s37, s43, 196608
    buffer_load_dwordx4 v8, s[8:11], s37 offen lds
    s_add_u32 m0, s34, 118784
    s_add_u32 s37, s44, 393216
    buffer_load_dwordx4 v9, s[20:23], s37 offen lds
    s_add_u32 m0, s34, 102400
    s_add_u32 s37, s43, 262144
    buffer_load_dwordx4 v8, s[8:11], s37 offen lds
    s_cmp_lg_u32 s51, 5
    s_cbranch_scc1 F_m3_5
    s_mov_b32 s6, 1
    s_atomic_add s6, s[60:61], 0x0 glc
F_m3_5:
    s_cmp_eq_u32 s7, 2
    s_cbranch_scc0 F_nokv5_2
    s_add_u32 m0, s34, 32768
    s_add_u32 s37, s46, 0
    buffer_load_dwordx4 v11, s[16:19], s37 offen nt lds
    s_add_u32 m0, s34, 36864
    s_add_u32 s37, s46, 4096
    buffer_load_dwordx4 v11, s[16:19], s37 offen nt lds
    s_add_u32 m0, s34, 40960
    s_add_u32 s37, s46, 8192
    buffer_load_dwordx4 v11, s[16:19], s37 offen nt lds
    s_add_u32 m0, s34, 45056
    s_add_u32 s37, s46, 12288
    buffer_load_dwordx4 v11, s[16:19], s37 offen nt lds
    s_add_u32 s37, s46, 32768
    buffer_load_dwordx4 v[80:83], v10, s[12:15], s37 offen nt
    s_add_u32 s37, s46, 36864
    buffer_load_dwordx4 v[84:87], v10, s[12:15], s37 offen nt
    s_add_u32 s37, s46, 40960
    buffer_load_dwordx4 v[88:91], v10, s[12:15], s37 offen nt
    s_add_u32 s37, s46, 45056
    buffer_load_dwordx4 v[92:95], v10, s[12:15], s37 offen nt
F_nokv5_2:
    s_cmp_eq_u32 s7, 1
    s_cbranch_scc1 F_w6_0
    s_cmp_eq_u32 s7, 2
    s_cbranch_scc1 F_w6_1
    s_waitcnt vmcnt(9)
    s_branch F_wd6
F_w6_0:
    s_waitcnt vmcnt(17)
    s_branch F_wd6
F_w6_1:
    s_waitcnt vmcnt(17)
F_wd6:
    s_barrier
    s_bfe_u32 s42, s5, 262144
    s_lshl_b32 s43, s42, 7
    s_add_u32 s43, s43, s47
    s_lshl_b32 s44, s42, 19
    s_add_u32 s44, s44, s48
    s_add_u32 m0, s34, 143360
    s_add_u32 s37, s44, 0
    buffer_load_dwordx4 v9, s[20:23], s37 offen lds
    s_add_u32 m0, s34, 122880
    s_add_u32 s37, s43, 0
    buffer_load_dwordx4 v8, s[8:11], s37 offen lds
    s_add_u32 m0, s34, 126976
    s_add_u32 s37, s43, 65536
    buffer_load_dwordx4 v8, s[8:11], s37 offen lds
    s_add_u32 m0, s34, 147456
    s_add_u32 s37, s44, 131072
    buffer_load_dwordx4 v9, s[20:23], s37 offen lds
    s_add_u32 m0, s34, 131072
    s_add_u32 s37, s43, 131072
    buffer_load_dwordx4 v8, s[8:11], s37 offen lds
    s_add_u32 m0, s34, 151552
    s_add_u32 s37, s44, 262144
    buffer_load_dwordx4 v9, s[20:23], s37 offen lds
    s_add_u32 m0, s34, 135168
    s_add_u32 s37, s43, 196608
    buffer_load_dwordx4 v8, s[8:11], s37 offen lds
    s_add_u32 m0, s34, 155648
    s_add_u32 s37, s44, 393216
    buffer_load_dwordx4 v9, s[20:23], s37 offen lds
    s_add_u32 m0, s34, 139264
    s_add_u32 s37, s43, 262144
    buffer_load_dwordx4 v8, s[8:11], s37 offen lds
    s_cmp_lg_u32 s51, 6
    s_cbranch_scc1 F_m3_6
    s_mov_b32 s6, 1
    s_atomic_add s6, s[60:61], 0x0 glc
F_m3_6:
    s_cmp_eq_u32 s7, 3
    s_cbranch_scc0 F_nokv6_3
    s_add_u32 m0, s34, 32768
    s_add_u32 s37, s46, 0
    buffer_load_dwordx4 v11, s[16:19], s37 offen nt lds
    s_add_u32 m0, s34, 36864
    s_add_u32 s37, s46, 4096
    buffer_load_dwordx4 v11, s[16:19], s37 offen nt lds
    s_add_u32 m0, s34, 40960
    s_add_u32 s37, s46, 8192
    buffer_load_dwordx4 v11, s[16:19], s37 offen nt lds
    s_add_u32 m0, s34, 45056
    s_add_u32 s37, s46, 12288
    buffer_load_dwordx4 v11, s[16:19], s37 offen nt lds
    s_add_u32 s37, s46, 32768
    buffer_load_dwordx4 v[80:83], v10, s[12:15], s37 offen nt
    s_add_u32 s37, s46, 36864
    buffer_load_dwordx4 v[84:87], v10, s[12:15], s37 offen nt
    s_add_u32 s37, s46, 40960
    buffer_load_dwordx4 v[88:91], v10, s[12:15], s37 offen nt
    s_add_u32 s37, s46, 45056
    buffer_load_dwordx4 v[92:95], v10, s[12:15], s37 offen nt
F_nokv6_3:
    s_cmp_eq_u32 s7, 2
    s_cbranch_scc1 F_w7_0
    s_cmp_eq_u32 s7, 3
    s_cbranch_scc1 F_w7_1
    s_waitcnt vmcnt(9)
    s_branch F_wd7
F_w7_0:
    s_waitcnt vmcnt(17)
    s_branch F_wd7
F_w7_1:
    s_waitcnt vmcnt(17)
F_wd7:
    s_barrier
    s_bfe_u32 s42, s5, 262148
    s_lshl_b32 s43, s42, 7
    s_add_u32 s43, s43, s47
    s_lshl_b32 s44, s42, 19
    s_add_u32 s44, s44, s48
    s_add_u32 m0, s34, 69632
    s_add_u32 s37, s44, 0
    buffer_load_dwordx4 v9, s[20:23], s37 offen lds
    s_add_u32 m0, s34, 49152
    s_add_u32 s37, s43, 0
    buffer_load_dwordx4 v8, s[8:11], s37 offen lds
    s_add_u32 m0, s34, 53248
    s_add_u32 s37, s43, 65536
    buffer_load_dwordx4 v8, s[8:11], s37 offen lds
    s_add_u32 m0, s34, 73728
    s_add_u32 s37, s44, 131072
    buffer_load_dwordx4 v9, s[20:23], s37 offen lds
    s_add_u32 m0, s34, 57344
    s_add_u32 s37, s43, 131072
    buffer_load_dwordx4 v8, s[8:11], s37 offen lds
    s_add_u32 m0, s34, 77824
    s_add_u32 s37, s44, 262144
    buffer_load_dwordx4 v9, s[20:23], s37 offen lds
    s_add_u32 m0, s34, 61440
    s_add_u32 s37, s43, 196608
    buffer_load_dwordx4 v8, s[8:11], s37 offen lds
    s_add_u32 m0, s34, 81920
    s_add_u32 s37, s44, 393216
    buffer_load_dwordx4 v9, s[20:23], s37 offen lds
    s_add_u32 m0, s34, 65536
    s_add_u32 s37, s43, 262144
    buffer_load_dwordx4 v8, s[8:11], s37 offen lds
    s_cmp_lg_u32 s51, 7
    s_cbranch_scc1 F_m3_7
    s_mov_b32 s6, 1
    s_atomic_add s6, s[60:61], 0x0 glc
F_m3_7:
    s_cmp_eq_u32 s7, 0
    s_cbranch_scc0 F_nokv7_0
    s_add_u32 s37, s46, 16384
    buffer_load_dwordx4 v[160:163], v11, s[16:19], s37 offen nt
    s_add_u32 s37, s46, 20480
    buffer_load_dwordx4 v[164:167], v11, s[16:19], s37 offen nt
    s_add_u32 s37, s46, 24576
    buffer_load_dwordx4 v[168:171], v11, s[16:19], s37 offen nt
    s_add_u32 s37, s46, 28672
    buffer_load_dwordx4 v[172:175], v11, s[16:19], s37 offen nt
    s_add_u32 s37, s46, 49152
    buffer_load_dwordx4 v[176:179], v10, s[12:15], s37 offen nt
F_nokv7_0:
    s_cmp_eq_u32 s7, 0
    s_cbranch_scc1 F_w8_0
    s_cmp_eq_u32 s7, 3
    s_cbranch_scc1 F_w8_1
    s_waitcnt vmcnt(9)
    s_branch F_wd8
F_w8_0:
    s_waitcnt vmcnt(14)
    s_branch F_wd8
F_w8_1:
    s_waitcnt vmcnt(17)
F_wd8:
    s_barrier
    s_bfe_u32 s42, s5, 262152
    s_lshl_b32 s43, s42, 7
    s_add_u32 s43, s43, s47
    s_lshl_b32 s44, s42, 19
    s_add_u32 s44, s44, s48
    s_add_u32 m0, s34, 106496
    s_add_u32 s37, s44, 0
    buffer_load_dwordx4 v9, s[20:23], s37 offen lds
    s_add_u32 m0, s34, 86016
    s_add_u32 s37, s43, 0
    buffer_load_dwordx4 v8, s[8:11], s37 offen lds
    s_add_u32 m0, s34, 90112
    s_add_u32 s37, s43, 65536
    buffer_load_dwordx4 v8, s[8:11], s37 offen lds
    s_add_u32 m0, s34, 110592
    s_add_u32 s37, s44, 131072
    buffer_load_dwordx4 v9, s[20:23], s37 offen lds
    s_add_u32 m0, s34, 94208
    s_add_u32 s37, s43, 131072
    buffer_load_dwordx4 v8, s[8:11], s37 offen lds
    s_add_u32 m0, s34, 114688
    s_add_u32 s37, s44, 262144
    buffer_load_dwordx4 v9, s[20:23], s37 offen lds
    s_add_u32 m0, s34, 98304
    s_add_u32 s37, s43, 196608
    buffer_load_dwordx4 v8, s[8:11], s37 offen lds
    s_add_u32 m0, s34, 118784
    s_add_u32 s37, s44, 393216
    buffer_load_dwordx4 v9, s[20:23], s37 offen lds
    s_add_u32 m0, s34, 102400
    s_add_u32 s37, s43, 262144
    buffer_load_dwordx4 v8, s[8:11], s37 offen lds
    s_cmp_lg_u32 s51, 8
    s_cbranch_scc1 F_m3_8
    s_mov_b32 s6, 1
    s_atomic_add s6, s[60:61], 0x0 glc
F_m3_8:
    s_cmp_eq_u32 s7, 1
    s_cbranch_scc0 F_nokv8_1
    s_add_u32 s37, s46, 16384
    buffer_load_dwordx4 v[160:163], v11, s[16:19], s37 offen nt
    s_add_u32 s37, s46, 20480
    buffer_load_dwordx4 v[164:167], v11, s[16:19], s37 offen nt
    s_add_u32 s37, s46, 24576
    buffer_load_dwordx4 v[168:171], v11, s[16:19], s37 offen nt
    s_add_u32 s37, s46, 28672
    buffer_load_dwordx4 v[172:175], v11, s[16:19], s37 offen nt
    s_add_u32 s37, s46, 49152
    buffer_load_dwordx4 v[176:179], v10, s[12:15], s37 offen nt
F_nokv8_1:
    s_cmp_eq_u32 s7, 0
    s_cbranch_scc1 F_w9_0
    s_cmp_eq_u32 s7, 1
    s_cbranch_scc1 F_w9_1
    s_waitcnt vmcnt(9)
    s_branch F_wd9
F_w9_0:
    s_waitcnt vmcnt(14)
    s_branch F_wd9
F_w9_1:
    s_waitcnt vmcnt(14)
F_wd9:
    s_barrier
    s_bfe_u32 s42, s5, 262156
    s_lshl_b32 s43, s42, 7
    s_add_u32 s43, s43, s47
    s_lshl_b32 s44, s42, 19
    s_add_u32 s44, s44, s48
    s_add_u32 m0, s34, 143360
    s_add_u32 s37, s44, 0
    buffer_load_dwordx4 v9, s[20:23], s37 offen lds
    s_add_u32 m0, s34, 122880
    s_add_u32 s37, s43, 0
    buffer_load_dwordx4 v8, s[8:11], s37 offen lds
    s_add_u32 m0, s34, 126976
    s_add_u32 s37, s43, 65536
    buffer_load_dwordx4 v8, s[8:11], s37 offen lds
    s_add_u32 m0, s34, 147456
    s_add_u32 s37, s44, 131072
    buffer_load_dwordx4 v9, s[20:23], s37 offen lds
    s_add_u32 m0, s34, 131072
    s_add_u32 s37, s43, 131072
    buffer_load_dwordx4 v8, s[8:11], s37 offen lds
    s_add_u32 m0, s34, 151552
    s_add_u32 s37, s44, 262144
    buffer_load_dwordx4 v9, s[20:23], s37 offen lds
    s_add_u32 m0, s34, 135168
    s_add_u32 s37, s43, 196608
    buffer_load_dwordx4 v8, s[8:11], s37 offen lds
    s_add_u32 m0, s34, 155648
    s_add_u32 s37, s44, 393216
    buffer_load_dwordx4 v9, s[20:23], s37 offen lds
    s_add_u32 m0, s34, 139264
    s_add_u32 s37, s43, 262144
    buffer_load_dwordx4 v8, s[8:11], s37 offen lds
    s_cmp_lg_u32 s51, 9
    s_cbranch_scc1 F_m3_9
    s_mov_b32 s6, 1
    s_atomic_add s6, s[60:61], 0x0 glc
F_m3_9:
    s_cmp_eq_u32 s7, 2
    s_cbranch_scc0 F_nokv9_2
    s_add_u32 s37, s46, 16384
    buffer_load_dwordx4 v[160:163], v11, s[16:19], s37 offen nt
    s_add_u32 s37, s46, 20480
    buffer_load_dwordx4 v[164:167], v11, s[16:19], s37 offen nt
    s_add_u32 s37, s46, 24576
    buffer_load_dwordx4 v[168:171], v11, s[16:19], s37 offen nt
    s_add_u32 s37, s46, 28672
    buffer_load_dwordx4 v[172:175], v11, s[16:19], s37 offen nt
    s_add_u32 s37, s46, 49152
    buffer_load_dwordx4 v[176:179], v10, s[12:15], s37 offen nt
F_nokv9_2:
    s_cmp_eq_u32 s7, 1
    s_cbranch_scc1 F_w10_0
    s_cmp_eq_u32 s7, 2
    s_cbranch_scc1 F_w10_1
    s_waitcnt vmcnt(9)
    s_branch F_wd10
F_w10_0:
    s_waitcnt vmcnt(14)
    s_branch F_wd10
F_w10_1:
    s_waitcnt vmcnt(14)
F_wd10:
    s_barrier
    s_bfe_u32 s42, s5, 262160
    s_lshl_b32 s43, s42, 7
    s_add_u32 s43, s43, s47
    s_lshl_b32 s44, s42, 19
    s_add_u32 s44, s44, s48
    s_add_u32 m0, s34, 69632
    s_add_u32 s37, s44, 0
    buffer_load_dwordx4 v9, s[20:23], s37 offen lds
    s_add_u32 m0, s34, 49152
    s_add_u32 s37, s43, 0
    buffer_load_dwordx4 v8, s[8:11], s37 offen lds
    s_add_u32 m0, s34, 53248
    s_add_u32 s37, s43, 65536
    buffer_load_dwordx4 v8, s[8:11], s37 offen lds
    s_add_u32 m0, s34, 73728
    s_add_u32 s37, s44, 131072
    buffer_load_dwordx4 v9, s[20:23], s37 offen lds
    s_add_u32 m0, s34, 57344
    s_add_u32 s37, s43, 131072
    buffer_load_dwordx4 v8, s[8:11], s37 offen lds
    s_add_u32 m0, s34, 77824
    s_add_u32 s37, s44, 262144
    buffer_load_dwordx4 v9, s[20:23], s37 offen lds
    s_add_u32 m0, s34, 61440
    s_add_u32 s37, s43, 196608
    buffer_load_dwordx4 v8, s[8:11], s37 offen lds
    s_add_u32 m0, s34, 81920
    s_add_u32 s37, s44, 393216
    buffer_load_dwordx4 v9, s[20:23], s37 offen lds
    s_add_u32 m0, s34, 65536
    s_add_u32 s37, s43, 262144
    buffer_load_dwordx4 v8, s[8:11], s37 offen lds
    s_cmp_lg_u32 s51, 10
    s_cbranch_scc1 F_m3_10
    s_mov_b32 s6, 1
    s_atomic_add s6, s[60:61], 0x0 glc
F_m3_10:
    s_cmp_eq_u32 s7, 3
    s_cbranch_scc0 F_nokv10_3
    s_add_u32 s37, s46, 16384
    buffer_load_dwordx4 v[160:163], v11, s[16:19], s37 offen nt
    s_add_u32 s37, s46, 20480
    buffer_load_dwordx4 v[164:167], v11, s[16:19], s37 offen nt
    s_add_u32 s37, s46, 24576
    buffer_load_dwordx4 v[168:171], v11, s[16:19], s37 offen nt
    s_add_u32 s37, s46, 28672
    buffer_load_dwordx4 v[172:175], v11, s[16:19], s37 offen nt
    s_add_u32 s37, s46, 49152
    buffer_load_dwordx4 v[176:179], v10, s[12:15], s37 offen nt
F_nokv10_3:
    s_cmp_eq_u32 s7, 2
    s_cbranch_scc1 F_w11_0
    s_cmp_eq_u32 s7, 3
    s_cbranch_scc1 F_w11_1
    s_waitcnt vmcnt(9)
    s_branch F_wd11
F_w11_0:
    s_waitcnt vmcnt(14)
    s_branch F_wd11
F_w11_1:
    s_waitcnt vmcnt(14)
F_wd11:
    s_barrier
    s_bfe_u32 s42, s5, 262164
    s_lshl_b32 s43, s42, 7
    s_add_u32 s43, s43, s47
    s_lshl_b32 s44, s42, 19
    s_add_u32 s44, s44, s48
    s_add_u32 m0, s34, 106496
    s_add_u32 s37, s44, 0
    buffer_load_dwordx4 v9, s[20:23], s37 offen lds
    s_add_u32 m0, s34, 86016
    s_add_u32 s37, s43, 0
    buffer_load_dwordx4 v8, s[8:11], s37 offen lds
    s_add_u32 m0, s34, 90112
    s_add_u32 s37, s43, 65536
    buffer_load_dwordx4 v8, s[8:11], s37 offen lds
    s_add_u32 m0, s34, 110592
    s_add_u32 s37, s44, 131072
    buffer_load_dwordx4 v9, s[20:23], s37 offen lds
    s_add_u32 m0, s34, 94208
    s_add_u32 s37, s43, 131072
    buffer_load_dwordx4 v8, s[8:11], s37 offen lds
    s_add_u32 m0, s34, 114688
    s_add_u32 s37, s44, 262144
    buffer_load_dwordx4 v9, s[20:23], s37 offen lds
    s_add_u32 m0, s34, 98304
    s_add_u32 s37, s43, 196608
    buffer_load_dwordx4 v8, s[8:11], s37 offen lds
    s_add_u32 m0, s34, 118784
    s_add_u32 s37, s44, 393216
    buffer_load_dwordx4 v9, s[20:23], s37 offen lds
    s_add_u32 m0, s34, 102400
    s_add_u32 s37, s43, 262144
    buffer_load_dwordx4 v8, s[8:11], s37 offen lds
    s_cmp_lg_u32 s51, 11
    s_cbranch_scc1 F_m3_11
    s_mov_b32 s6, 1
    s_atomic_add s6, s[60:61], 0x0 glc
F_m3_11:
    s_cmp_eq_u32 s7, 3
    s_cbranch_scc1 F_w12_0
    s_waitcnt vmcnt(9)
    s_branch F_wd12
F_w12_0:
    s_waitcnt vmcnt(14)
F_wd12:
    s_barrier
    s_bfe_u32 s42, s5, 262168
    s_lshl_b32 s43, s42, 7
    s_add_u32 s43, s43, s47
    s_lshl_b32 s44, s42, 19
    s_add_u32 s44, s44, s48
    s_add_u32 m0, s34, 143360
    s_add_u32 s37, s44, 0
    buffer_load_dwordx4 v9, s[20:23], s37 offen lds
    s_add_u32 m0, s34, 122880
    s_add_u32 s37, s43, 0
    buffer_load_dwordx4 v8, s[8:11], s37 offen lds
    s_add_u32 m0, s34, 126976
    s_add_u32 s37, s43, 65536
    buffer_load_dwordx4 v8, s[8:11], s37 offen lds
    s_add_u32 m0, s34, 147456
    s_add_u32 s37, s44, 131072
    buffer_load_dwordx4 v9, s[20:23], s37 offen lds
    s_add_u32 m0, s34, 131072
    s_add_u32 s37, s43, 131072
    buffer_load_dwordx4 v8, s[8:11], s37 offen lds
    s_add_u32 m0, s34, 151552
    s_add_u32 s37, s44, 262144
    buffer_load_dwordx4 v9, s[20:23], s37 offen lds
    s_add_u32 m0, s34, 135168
    s_add_u32 s37, s43, 196608
    buffer_load_dwordx4 v8, s[8:11], s37 offen lds
    s_add_u32 m0, s34, 155648
    s_add_u32 s37, s44, 393216
    buffer_load_dwordx4 v9, s[20:23], s37 offen lds
    s_add_u32 m0, s34, 139264
    s_add_u32 s37, s43, 262144
    buffer_load_dwordx4 v8, s[8:11], s37 offen lds
    s_cmp_lg_u32 s51, 12
    s_cbranch_scc1 F_m3_12
    s_mov_b32 s6, 1
    s_atomic_add s6, s[60:61], 0x0 glc
F_m3_12:
    s_waitcnt vmcnt(9)
    s_barrier
    s_bfe_u32 s42, s5, 262172
    s_lshl_b32 s43, s42, 7
    s_add_u32 s43, s43, s47
    s_lshl_b32 s44, s42, 19
    s_add_u32 s44, s44, s48
    s_add_u32 m0, s34, 69632
    s_add_u32 s37, s44, 0
    buffer_load_dwordx4 v9, s[20:23], s37 offen lds
    s_add_u32 m0, s34, 49152
    s_add_u32 s37, s43, 0
    buffer_load_dwordx4 v8, s[8:11], s37 offen lds
    s_add_u32 m0, s34, 53248
    s_add_u32 s37, s43, 65536
    buffer_load_dwordx4 v8, s[8:11], s37 offen lds
    s_add_u32 m0, s34, 73728
    s_add_u32 s37, s44, 131072
    buffer_load_dwordx4 v9, s[20:23], s37 offen lds
    s_add_u32 m0, s34, 57344
    s_add_u32 s37, s43, 131072
    buffer_load_dwordx4 v8, s[8:11], s37 offen lds
    s_add_u32 m0, s34, 77824
    s_add_u32 s37, s44, 262144
    buffer_load_dwordx4 v9, s[20:23], s37 offen lds
    s_add_u32 m0, s34, 61440
    s_add_u32 s37, s43, 196608
    buffer_load_dwordx4 v8, s[8:11], s37 offen lds
    s_add_u32 m0, s34, 81920
    s_add_u32 s37, s44, 393216
    buffer_load_dwordx4 v9, s[20:23], s37 offen lds
    s_add_u32 m0, s34, 65536
    s_add_u32 s37, s43, 262144
    buffer_load_dwordx4 v8, s[8:11], s37 offen lds
    s_add_u32 s37, s46, 53248
    buffer_load_dwordx4 v[180:183], v10, s[12:15], s37 offen nt
    s_add_u32 s37, s46, 57344
    buffer_load_dwordx4 v[184:187], v10, s[12:15], s37 offen nt
    s_add_u32 s37, s46, 61440
    buffer_load_dwordx4 v[188:191], v10, s[12:15], s37 offen nt
    s_waitcnt vmcnt(12)
    s_barrier
    s_add_u32 m0, s34, 98304
    s_add_u32 s37, s46, 32768
    buffer_load_dwordx4 v11, s[16:19], s37 offen nt lds
    s_add_u32 m0, s34, 102400
    s_add_u32 s37, s46, 36864
    buffer_load_dwordx4 v11, s[16:19], s37 offen nt lds
    s_add_u32 m0, s34, 106496
    s_add_u32 s37, s46, 40960
    buffer_load_dwordx4 v11, s[16:19], s37 offen nt lds
    s_add_u32 m0, s34, 110592
    s_add_u32 s37, s46, 45056
    buffer_load_dwordx4 v11, s[16:19], s37 offen nt lds
    s_branch F_h2
.p2align 12
.fill 320, 4, 0xbf800000
F_h2:
    s_mov_b32 s4, s55
    s_lshl_b32 s5, s54, 3
    s_bfe_u32 s47, s4, 196608
    s_add_u32 s47, s47, s5
    s_lshl_b32 s47, s47, 18
    s_bfe_u32 s48, s4, 196612
    s_add_u32 s48, s48, s5
    s_lshl_b32 s48, s48, 18
    s_lshl_b32 s51, s29, 2
    s_add_u32 s51, s51, s54
    s_lshl_b32 s51, s51, 10
    s_add_u32 s51, s51, 16777216
    s_mov_b32 s8, 49152
    s_mov_b32 s9, 59392
    s_mov_b32 s10, 0
    s_mov_b32 s11, 10240
    s_cmp_eq_u32 s31, 1
    s_cmov_b32 s8, 54272
    s_cmov_b32 s9, 67584
    s_cmov_b32 s10, 5120
    s_cmov_b32 s11, 83968
    s_cmp_eq_u32 s31, 2
    s_cmov_b32 s8, 16384
    s_cmov_b32 s9, 26624
    s_cmov_b32 s10, 32768
    s_cmov_b32 s11, 43008
    s_cmp_eq_u32 s31, 3
    s_cmov_b32 s8, 21504
    s_cmov_b32 s9, 72704
    s_cmov_b32 s10, 37888
    s_cmov_b32 s11, 89088
    s_lshr_b32 s42, s31, 1
    s_lshl_b32 s43, s29, 1
    s_add_u32 s42, s42, s43
    s_mul_i32 s42, s42, 5
    s_and_b32 s44, s31, 1
    s_mul_i32 s44, s44, 2048
    s_add_u32 s3, s42, 0
    s_and_b32 s22, s3, 1
    s_lshl_b32 s22, s22, 8
    s_lshr_b32 s3, s3, 1
    s_mul_i32 s3, s3, 263168
    s_add_u32 s3, s3, s44
    s_add_u32 s3, s3, s22
    s_add_u32 s20, s3, 8192
    s_add_u32 s3, s42, 1
    s_and_b32 s23, s3, 1
    s_lshl_b32 s23, s23, 8
    s_lshr_b32 s3, s3, 1
    s_mul_i32 s3, s3, 263168
    s_add_u32 s3, s3, s44
    s_add_u32 s3, s3, s23
    s_add_u32 s21, s3, 7168
    s_lshl_b32 s49, s31, 12
    v_lshlrev_b32 v2, 4, v1
    v_add_u32 v3, 1024, v2
    s_lshl_b32 s42, s31, 9
    s_add_u32 s42, s42, 65536
    v_lshlrev_b32 v7, 3, v1
    v_add_u32 v8, s42, v7
    v_lshlrev_b32 v6, 4, v1
    s_xor_b32 s42, s31, 1
    s_lshl_b32 s42, s42, 12
    s_add_u32 s42, s42, 0
    v_add_u32 v9, s42, v6
    s_xor_b32 s42, s31, 2
    s_lshl_b32 s42, s42, 12
    s_add_u32 s42, s42, 32768
    v_add_u32 v0, s42, v6
    s_xor_b32 s42, s31, 3
    s_lshl_b32 s42, s42, 12
    s_add_u32 s42, s42, 81920
    v_add_u32 v5, s42, v6
    v_lshlrev_b32 v6, 4, v1
    v_add_u32 v7, 81920, v6
    s_waitcnt vmcnt(7)
    s_barrier
    s_add_u32 m0, s34, 114688
    s_add_u32 s37, s46, 65536
    buffer_load_dwordx4 v10, s[12:15], s37 offen nt lds
    s_add_u32 m0, s34, 118784
    s_add_u32 s37, s46, 69632
    buffer_load_dwordx4 v10, s[12:15], s37 offen nt lds
    s_add_u32 m0, s34, 122880
    s_add_u32 s37, s46, 73728
    buffer_load_dwordx4 v10, s[12:15], s37 offen nt lds
    s_add_u32 m0, s34, 126976
    s_add_u32 s37, s46, 77824
    buffer_load_dwordx4 v10, s[12:15], s37 offen nt lds
    s_barrier
    s_add_u32 m0, s34, 131072
    s_add_u32 s37, s46, 49152
    buffer_load_dwordx4 v11, s[16:19], s37 offen nt lds
    s_add_u32 m0, s34, 135168
    s_add_u32 s37, s46, 53248
    buffer_load_dwordx4 v11, s[16:19], s37 offen nt lds
    s_add_u32 m0, s34, 139264
    s_add_u32 s37, s46, 57344
    buffer_load_dwordx4 v11, s[16:19], s37 offen nt lds
    s_add_u32 m0, s34, 143360
    s_add_u32 s37, s46, 61440
    buffer_load_dwordx4 v11, s[16:19], s37 offen nt lds
    s_barrier
    ds_read_b128 v[32:35], v7 offset:0
    ds_read_b128 v[36:39], v7 offset:1024
    ds_read_b128 v[40:43], v7 offset:2048
    ds_read_b128 v[44:47], v7 offset:3072
    ds_read_b128 v[48:51], v7 offset:4096
    ds_read_b128 v[52:55], v7 offset:5120
    ds_read_b128 v[56:59], v7 offset:6144
    ds_read_b128 v[60:63], v7 offset:7168
    s_add_u32 m0, s34, 147456
    s_add_u32 s37, s46, 81920
    buffer_load_dwordx4 v10, s[12:15], s37 offen nt lds
    s_add_u32 m0, s34, 151552
    s_add_u32 s37, s46, 86016
    buffer_load_dwordx4 v10, s[12:15], s37 offen nt lds
    s_add_u32 m0, s34, 155648
    s_add_u32 s37, s46, 90112
    buffer_load_dwordx4 v10, s[12:15], s37 offen nt lds
    s_add_u32 m0, s34, 159744
    s_add_u32 s37, s46, 94208
    buffer_load_dwordx4 v10, s[12:15], s37 offen nt lds
    s_cmp_ge_u32 s31, 2
    s_cselect_b32 s39, 1, 0
    s_lshl_b32 s39, s39, 14
    s_sub_u32 s37, s39, s35
    s_mov_b32 s35, s39
    v_add_u32 v16, s37, v16
    v_add_u32 v17, s37, v17
    v_add_u32 v18, s37, v18
    v_add_u32 v19, s37, v19
    v_add_u32 v20, s37, v20
    v_add_u32 v21, s37, v21
    v_add_u32 v22, s37, v22
    v_add_u32 v23, s37, v23
    s_waitcnt vmcnt(38) lgkmcnt(0)
    s_barrier
    ds_read_b128 v[128:131], v16 offset:0
    ds_read_b128 v[132:135], v17 offset:0
    ds_read_b128 v[136:139], v18 offset:0
    ds_read_b128 v[140:143], v19 offset:0
    ds_read_b128 v[144:147], v20 offset:0
    ds_read_b128 v[148:151], v21 offset:0
    ds_read_b128 v[152:155], v22 offset:0
    ds_read_b128 v[156:159], v23 offset:0
    s_add_u32 m0, s34, 81920
    s_add_u32 s37, s46, 65536
    buffer_load_dwordx4 v11, s[16:19], s37 offen nt lds
    s_add_u32 m0, s34, 86016
    s_add_u32 s37, s46, 69632
    buffer_load_dwordx4 v11, s[16:19], s37 offen nt lds
    s_waitcnt lgkmcnt(0)
    s_setprio 1
    v_mfma_f32_32x32x16_bf16 v[64:79], v[128:131], v[32:35], v[96:111]
    v_mfma_f32_32x32x16_bf16 v[64:79], v[132:135], v[36:39], v[64:79]
    v_mfma_f32_32x32x16_bf16 v[64:79], v[136:139], v[40:43], v[64:79]
    v_mfma_f32_32x32x16_bf16 v[64:79], v[140:143], v[44:47], v[64:79]
    v_mfma_f32_32x32x16_bf16 v[64:79], v[144:147], v[48:51], v[64:79]
    v_mfma_f32_32x32x16_bf16 v[64:79], v[148:151], v[52:55], v[64:79]
    v_mfma_f32_32x32x16_bf16 v[64:79], v[152:155], v[56:59], v[64:79]
    v_mfma_f32_32x32x16_bf16 v[64:79], v[156:159], v[60:63], v[64:79]
    s_setprio 0
    s_nop 11
    v_add_u32 v120, 49152, v12
    ds_write_b128 v120, v[80:83] offset:0
    v_exp_f32 v122, v64
    v_exp_f32 v123, v65
    v_exp_f32 v124, v66
    ds_write_b128 v120, v[84:87] offset:4096
    v_exp_f32 v125, v67
    v_add_f32 v15, v122, v123
    ds_write_b128 v120, v[88:91] offset:8192
    v_cvt_pk_bf16_f32 v112, v122, v123
    v_exp_f32 v126, v68
    ds_write_b128 v120, v[92:95] offset:12288
    v_exp_f32 v127, v69
    v_add_f32 v28, v124, v125
    v_add_u32 v120, 65536, v12
    ds_write_b128 v120, v[160:163] offset:0
    v_cvt_pk_bf16_f32 v113, v124, v125
    v_exp_f32 v122, v70
    v_exp_f32 v123, v71
    ds_write_b128 v120, v[164:167] offset:4096
    v_add_f32 v15, v15, v126
    v_add_f32 v28, v28, v127
    ds_write_b128 v120, v[168:171] offset:8192
    v_cvt_pk_bf16_f32 v114, v126, v127
    v_add_f32 v15, v15, v122
    ds_write_b128 v120, v[172:175] offset:12288
    v_add_f32 v28, v28, v123
    v_cvt_pk_bf16_f32 v115, v122, v123
    s_add_u32 m0, s34, 90112
    s_add_u32 s37, s46, 73728
    buffer_load_dwordx4 v11, s[16:19], s37 offen nt lds
    s_add_u32 m0, s34, 94208
    s_add_u32 s37, s46, 77824
    buffer_load_dwordx4 v11, s[16:19], s37 offen nt lds
    s_cmp_ge_u32 s31, 2
    s_cselect_b32 s39, 4, 2
    s_lshl_b32 s39, s39, 14
    s_sub_u32 s37, s39, s36
    s_mov_b32 s36, s39
    v_add_u32 v24, s37, v24
    v_add_u32 v25, s37, v25
    v_add_u32 v26, s37, v26
    v_add_u32 v27, s37, v27
    s_waitcnt vmcnt(42) lgkmcnt(0)
    s_barrier
    ds_read_b64_tr_b16 v[128:129], v24 offset:0
    ds_read_b64_tr_b16 v[130:131], v24 offset:2048
    ds_read_b64_tr_b16 v[132:133], v25 offset:0
    ds_read_b64_tr_b16 v[134:135], v25 offset:2048
    ds_read_b64_tr_b16 v[136:137], v26 offset:0
    ds_read_b64_tr_b16 v[138:139], v26 offset:2048
    ds_read_b64_tr_b16 v[140:141], v27 offset:0
    ds_read_b64_tr_b16 v[142:143], v27 offset:2048
    ds_read_b64_tr_b16 v[144:145], v24 offset:4096
    ds_read_b64_tr_b16 v[146:147], v24 offset:6144
    ds_read_b64_tr_b16 v[148:149], v25 offset:4096
    ds_read_b64_tr_b16 v[150:151], v25 offset:6144
    v_exp_f32 v124, v72
    v_exp_f32 v125, v73
    v_exp_f32 v126, v74
    v_exp_f32 v127, v75
    v_add_f32 v15, v15, v124
    v_add_f32 v28, v28, v125
    ds_read_b64_tr_b16 v[152:153], v26 offset:4096
    ds_read_b64_tr_b16 v[154:155], v26 offset:6144
    ds_read_b64_tr_b16 v[156:157], v27 offset:4096
    ds_read_b64_tr_b16 v[158:159], v27 offset:6144
    v_cvt_pk_bf16_f32 v116, v124, v125
    v_exp_f32 v122, v76
    v_exp_f32 v123, v77
    v_add_f32 v15, v15, v126
    v_add_f32 v28, v28, v127
    v_cvt_pk_bf16_f32 v117, v126, v127
    v_exp_f32 v124, v78
    v_exp_f32 v125, v79
    v_add_f32 v15, v15, v122
    v_add_f32 v28, v28, v123
    v_cvt_pk_bf16_f32 v118, v122, v123
    v_add_f32 v15, v15, v124
    v_add_f32 v28, v28, v125
    v_cvt_pk_bf16_f32 v119, v124, v125
    v_add_f32 v15, v15, v28
    v_mov_b32 v29, 0x38800000
    v_med3_f32 v29, v15, s32, v29
    v_cmp_neq_f32 vcc, v29, v15
    s_nop 3
    s_cbranch_vccnz F_tr_h0
F_bk_h0:
    v_add_f32 v14, v14, v15
    s_add_u32 m0, s34, 0
    s_add_u32 s37, s46, 98304
    buffer_load_dwordx4 v10, s[12:15], s37 offen nt lds
    s_add_u32 m0, s34, 4096
    s_add_u32 s37, s46, 102400
    buffer_load_dwordx4 v10, s[12:15], s37 offen nt lds
    s_waitcnt lgkmcnt(0)
    s_setprio 1
    s_waitcnt vmcnt(22)
    v_add_u32 v120, 16384, v12
    ds_write_b128 v120, v[176:179] offset:0
    v_mfma_f32_32x32x16_bf16 v[192:207], v[128:131], v[112:115], 0
    v_mfma_f32_32x32x16_bf16 v[208:223], v[132:135], v[112:115], 0
    ds_write_b128 v120, v[180:183] offset:4096
    v_mfma_f32_32x32x16_bf16 v[224:239], v[136:139], v[112:115], 0
    v_mfma_f32_32x32x16_bf16 v[240:255], v[140:143], v[112:115], 0
    ds_write_b128 v120, v[184:187] offset:8192
    v_mfma_f32_32x32x16_bf16 v[192:207], v[144:147], v[116:119], v[192:207]
    v_mfma_f32_32x32x16_bf16 v[208:223], v[148:151], v[116:119], v[208:223]
    ds_write_b128 v120, v[188:191] offset:12288
    v_mfma_f32_32x32x16_bf16 v[224:239], v[152:155], v[116:119], v[224:239]
    v_mfma_f32_32x32x16_bf16 v[240:255], v[156:159], v[116:119], v[240:255]
    s_setprio 0
    s_add_u32 m0, s34, 8192
    s_add_u32 s37, s46, 106496
    buffer_load_dwordx4 v10, s[12:15], s37 offen nt lds
    s_add_u32 m0, s34, 12288
    s_add_u32 s37, s46, 110592
    buffer_load_dwordx4 v10, s[12:15], s37 offen nt lds
    s_cmp_ge_u32 s31, 2
    s_cselect_b32 s39, 1, 3
    s_lshl_b32 s39, s39, 14
    s_sub_u32 s37, s39, s35
    s_mov_b32 s35, s39
    v_add_u32 v16, s37, v16
    v_add_u32 v17, s37, v17
    v_add_u32 v18, s37, v18
    v_add_u32 v19, s37, v19
    v_add_u32 v20, s37, v20
    v_add_u32 v21, s37, v21
    v_add_u32 v22, s37, v22
    v_add_u32 v23, s37, v23
    s_waitcnt vmcnt(20) lgkmcnt(0)
    s_barrier
    ds_read_b128 v[128:131], v16 offset:0
    ds_read_b128 v[132:135], v17 offset:0
    ds_read_b128 v[136:139], v18 offset:0
    ds_read_b128 v[140:143], v19 offset:0
    ds_read_b128 v[144:147], v20 offset:0
    ds_read_b128 v[148:151], v21 offset:0
    ds_read_b128 v[152:155], v22 offset:0
    ds_read_b128 v[156:159], v23 offset:0
    s_add_u32 m0, s34, 65536
    s_add_u32 s37, s46, 81920
    buffer_load_dwordx4 v11, s[16:19], s37 offen nt lds
    s_add_u32 m0, s34, 69632
    s_add_u32 s37, s46, 86016
    buffer_load_dwordx4 v11, s[16:19], s37 offen nt lds
    s_add_u32 m0, s34, 73728
    s_add_u32 s37, s46, 90112
    buffer_load_dwordx4 v11, s[16:19], s37 offen nt lds
    s_waitcnt lgkmcnt(0)
    s_setprio 1
    v_mfma_f32_32x32x16_bf16 v[64:79], v[128:131], v[32:35], v[96:111]
    v_mfma_f32_32x32x16_bf16 v[64:79], v[132:135], v[36:39], v[64:79]
    v_mfma_f32_32x32x16_bf16 v[64:79], v[136:139], v[40:43], v[64:79]
    v_mfma_f32_32x32x16_bf16 v[64:79], v[140:143], v[44:47], v[64:79]
    v_mfma_f32_32x32x16_bf16 v[64:79], v[144:147], v[48:51], v[64:79]
    v_mfma_f32_32x32x16_bf16 v[64:79], v[148:151], v[52:55], v[64:79]
    v_mfma_f32_32x32x16_bf16 v[64:79], v[152:155], v[56:59], v[64:79]
    v_mfma_f32_32x32x16_bf16 v[64:79], v[156:159], v[60:63], v[64:79]
    s_setprio 0
    s_getpc_b64 s[40:41]
F_pc2:
    s_sub_u32 s40, s40, F_pc2-F_begin
    s_subb_u32 s41, s41, 0
    s_lshr_b32 s42, s2, 3
    s_mul_i32 s42, s42, 1920
    v_and_b32 v6, 15, v1
    v_lshlrev_b32 v6, 7, v6
    v_add_u32 v6, s42, v6
    s_mov_b32 s42, F_last-F_begin
    v_min_u32 v6, s42, v6
    global_load_dword v165, v6, s[40:41]
    v_mov_b32 v6, 0
    buffer_load_dword v121, v6, s[60:63], 0 offen sc1
    s_nop 11
    v_exp_f32 v122, v64
    v_exp_f32 v123, v65
    v_exp_f32 v124, v66
    v_exp_f32 v125, v67
    v_add_f32 v15, v122, v123
    v_cvt_pk_bf16_f32 v112, v122, v123
    v_exp_f32 v126, v68
    v_exp_f32 v127, v69
    v_add_f32 v28, v124, v125
    v_cvt_pk_bf16_f32 v113, v124, v125
    v_exp_f32 v122, v70
    v_exp_f32 v123, v71
    v_add_f32 v15, v15, v126
    v_add_f32 v28, v28, v127
    v_cvt_pk_bf16_f32 v114, v126, v127
    v_add_f32 v15, v15, v122
    v_add_f32 v28, v28, v123
    v_cvt_pk_bf16_f32 v115, v122, v123
    v_lshrrev_b32 v160, 4, v1
    v_and_b32 v161, 15, v1
    v_lshlrev_b32 v160, 9, v160
    v_lshl_add_u32 v160, v161, 4, v160
    v_add_u32 v161, s21, v160
    v_add_u32 v160, s20, v160
    v_add_u32 v162, 261120, v160
    v_add_u32 v163, 261120, v161
    v_add_u32 v164, 526336, v160
    s_add_u32 m0, s34, 77824
    s_add_u32 s37, s46, 94208
    buffer_load_dwordx4 v11, s[16:19], s37 offen nt lds
    s_add_u32 m0, s34, 32768
    s_add_u32 s37, s46, 114688
    buffer_load_dwordx4 v10, s[12:15], s37 offen nt lds
    s_add_u32 m0, s34, 36864
    s_add_u32 s37, s46, 118784
    buffer_load_dwordx4 v10, s[12:15], s37 offen nt lds
    s_cmp_ge_u32 s31, 2
    s_cselect_b32 s39, 8, 6
    s_lshl_b32 s39, s39, 14
    s_sub_u32 s37, s39, s36
    s_mov_b32 s36, s39
    v_add_u32 v24, s37, v24
    v_add_u32 v25, s37, v25
    v_add_u32 v26, s37, v26
    v_add_u32 v27, s37, v27
    s_waitcnt vmcnt(20) lgkmcnt(0)
    s_barrier
    ds_read_b64_tr_b16 v[128:129], v24 offset:0
    ds_read_b64_tr_b16 v[130:131], v24 offset:2048
    ds_read_b64_tr_b16 v[132:133], v25 offset:0
    ds_read_b64_tr_b16 v[134:135], v25 offset:2048
    ds_read_b64_tr_b16 v[136:137], v26 offset:0
    ds_read_b64_tr_b16 v[138:139], v26 offset:2048
    ds_read_b64_tr_b16 v[140:141], v27 offset:0
    ds_read_b64_tr_b16 v[142:143], v27 offset:2048
    ds_read_b64_tr_b16 v[144:145], v24 offset:4096
    ds_read_b64_tr_b16 v[146:147], v24 offset:6144
    ds_read_b64_tr_b16 v[148:149], v25 offset:4096
    ds_read_b64_tr_b16 v[150:151], v25 offset:6144
    v_exp_f32 v124, v72
    v_exp_f32 v125, v73
    v_exp_f32 v126, v74
    v_exp_f32 v127, v75
    v_add_f32 v15, v15, v124
    v_add_f32 v28, v28, v125
    ds_read_b64_tr_b16 v[152:153], v26 offset:4096
    ds_read_b64_tr_b16 v[154:155], v26 offset:6144
    ds_read_b64_tr_b16 v[156:157], v27 offset:4096
    ds_read_b64_tr_b16 v[158:159], v27 offset:6144
    v_cvt_pk_bf16_f32 v116, v124, v125
    v_exp_f32 v122, v76
    v_exp_f32 v123, v77
    v_add_f32 v15, v15, v126
    v_add_f32 v28, v28, v127
    v_cvt_pk_bf16_f32 v117, v126, v127
    v_exp_f32 v124, v78
    v_exp_f32 v125, v79
    v_add_f32 v15, v15, v122
    v_add_f32 v28, v28, v123
    v_cvt_pk_bf16_f32 v118, v122, v123
    v_add_f32 v15, v15, v124
    v_add_f32 v28, v28, v125
    v_cvt_pk_bf16_f32 v119, v124, v125
    v_add_f32 v15, v15, v28
    v_cmp_lt_f32 vcc, s32, v15
    s_nop 3
    s_cbranch_vccnz F_tr_h1
F_bk_h1:
    v_add_f32 v14, v14, v15
    s_add_u32 m0, s34, 40960
    s_add_u32 s37, s46, 122880
    buffer_load_dwordx4 v10, s[12:15], s37 offen nt lds
    s_add_u32 m0, s34, 45056
    s_add_u32 s37, s46, 126976
    buffer_load_dwordx4 v10, s[12:15], s37 offen nt lds
    s_add_u32 m0, s34, 49152
    s_add_u32 s37, s46, 98304
    buffer_load_dwordx4 v11, s[16:19], s37 offen nt lds
    s_waitcnt lgkmcnt(0)
    s_setprio 1
    v_mfma_f32_32x32x16_bf16 v[192:207], v[128:131], v[112:115], v[192:207]
    v_mfma_f32_32x32x16_bf16 v[208:223], v[132:135], v[112:115], v[208:223]
    v_mfma_f32_32x32x16_bf16 v[224:239], v[136:139], v[112:115], v[224:239]
    v_mfma_f32_32x32x16_bf16 v[240:255], v[140:143], v[112:115], v[240:255]
    v_mfma_f32_32x32x16_bf16 v[192:207], v[144:147], v[116:119], v[192:207]
    v_mfma_f32_32x32x16_bf16 v[208:223], v[148:151], v[116:119], v[208:223]
    v_mfma_f32_32x32x16_bf16 v[224:239], v[152:155], v[116:119], v[224:239]
    v_mfma_f32_32x32x16_bf16 v[240:255], v[156:159], v[116:119], v[240:255]
    s_setprio 0
    v_xor_b32 v91, 128, v13
    v_add_u32 v89, 7168, v91
    v_add_u32 v90, 14336, v13
    v_add_u32 v91, 21504, v91
    s_add_u32 m0, s34, 53248
    s_add_u32 s37, s46, 102400
    buffer_load_dwordx4 v11, s[16:19], s37 offen nt lds
    s_add_u32 m0, s34, 57344
    s_add_u32 s37, s46, 106496
    buffer_load_dwordx4 v11, s[16:19], s37 offen nt lds
    s_add_u32 m0, s34, 61440
    s_add_u32 s37, s46, 110592
    buffer_load_dwordx4 v11, s[16:19], s37 offen nt lds
    s_cmp_ge_u32 s31, 2
    s_cselect_b32 s39, 9, 7
    s_lshl_b32 s39, s39, 14
    s_sub_u32 s37, s39, s35
    s_mov_b32 s35, s39
    v_add_u32 v16, s37, v16
    v_add_u32 v17, s37, v17
    v_add_u32 v18, s37, v18
    v_add_u32 v19, s37, v19
    v_add_u32 v20, s37, v20
    v_add_u32 v21, s37, v21
    v_add_u32 v22, s37, v22
    v_add_u32 v23, s37, v23
    s_waitcnt vmcnt(18) lgkmcnt(0)
    s_barrier
    ds_read_b128 v[128:131], v16 offset:0
    ds_read_b128 v[132:135], v17 offset:0
    ds_read_b128 v[136:139], v18 offset:0
    ds_read_b128 v[140:143], v19 offset:0
    ds_read_b128 v[144:147], v20 offset:0
    ds_read_b128 v[148:151], v21 offset:0
    ds_read_b128 v[152:155], v22 offset:0
    ds_read_b128 v[156:159], v23 offset:0
    s_add_u32 m0, s34, 16384
    s_add_u32 s37, s46, 114688
    buffer_load_dwordx4 v11, s[16:19], s37 offen nt lds
    s_add_u32 m0, s34, 20480
    s_add_u32 s37, s46, 118784
    buffer_load_dwordx4 v11, s[16:19], s37 offen nt lds
    s_add_u32 m0, s34, 24576
    s_add_u32 s37, s46, 122880
    buffer_load_dwordx4 v11, s[16:19], s37 offen nt lds
    s_waitcnt lgkmcnt(0)
    s_setprio 1
    v_mfma_f32_32x32x16_bf16 v[64:79], v[128:131], v[32:35], v[96:111]
    v_mfma_f32_32x32x16_bf16 v[64:79], v[132:135], v[36:39], v[64:79]
    v_mfma_f32_32x32x16_bf16 v[64:79], v[136:139], v[40:43], v[64:79]
    v_mfma_f32_32x32x16_bf16 v[64:79], v[140:143], v[44:47], v[64:79]
    v_mfma_f32_32x32x16_bf16 v[64:79], v[144:147], v[48:51], v[64:79]
    v_mfma_f32_32x32x16_bf16 v[64:79], v[148:151], v[52:55], v[64:79]
    v_mfma_f32_32x32x16_bf16 v[64:79], v[152:155], v[56:59], v[64:79]
    v_mfma_f32_32x32x16_bf16 v[64:79], v[156:159], v[60:63], v[64:79]
    s_setprio 0
    s_nop 11
    v_exp_f32 v122, v64
    v_exp_f32 v123, v65
    v_exp_f32 v124, v66
    v_exp_f32 v125, v67
    v_add_f32 v15, v122, v123
    v_cvt_pk_bf16_f32 v112, v122, v123
    v_exp_f32 v126, v68
    v_exp_f32 v127, v69
    v_add_f32 v28, v124, v125
    v_cvt_pk_bf16_f32 v113, v124, v125
    v_exp_f32 v122, v70
    v_exp_f32 v123, v71
    v_add_f32 v15, v15, v126
    v_add_f32 v28, v28, v127
    v_cvt_pk_bf16_f32 v114, v126, v127
    v_add_f32 v15, v15, v122
    v_add_f32 v28, v28, v123
    v_cvt_pk_bf16_f32 v115, v122, v123
    v_and_b32 v92, 7, v1
    v_lshlrev_b32 v92, 2, v92
    v_lshrrev_b32 v92, v92, s4
    v_and_b32 v92, 7, v92
    v_lshlrev_b32 v92, 7, v92
    s_waitcnt vmcnt(12)
    v_cmp_gt_u32 vcc, 0x100, v121
    s_cbranch_vccnz F_cnt
F_cntd:
    s_add_u32 m0, s34, 28672
    s_add_u32 s37, s46, 126976
    buffer_load_dwordx4 v11, s[16:19], s37 offen nt lds
    s_add_u32 m0, s49, 98304
    s_add_u32 s33, s47, 0
    buffer_load_dwordx4 v13, s[56:59], s33 offen offset:0 lds
    buffer_load_dwordx4 v89, s[56:59], s33 offen offset:1024 lds
    s_cmp_ge_u32 s31, 2
    s_cselect_b32 s39, 4, 5
    s_lshl_b32 s39, s39, 14
    s_sub_u32 s37, s39, s36
    s_mov_b32 s36, s39
    v_add_u32 v24, s37, v24
    v_add_u32 v25, s37, v25
    v_add_u32 v26, s37, v26
    v_add_u32 v27, s37, v27
    s_waitcnt vmcnt(14) lgkmcnt(0)
    s_barrier
    ds_read_b64_tr_b16 v[128:129], v24 offset:0
    ds_read_b64_tr_b16 v[130:131], v24 offset:2048
    ds_read_b64_tr_b16 v[132:133], v25 offset:0
    ds_read_b64_tr_b16 v[134:135], v25 offset:2048
    ds_read_b64_tr_b16 v[136:137], v26 offset:0
    ds_read_b64_tr_b16 v[138:139], v26 offset:2048
    ds_read_b64_tr_b16 v[140:141], v27 offset:0
    ds_read_b64_tr_b16 v[142:143], v27 offset:2048
    ds_read_b64_tr_b16 v[144:145], v24 offset:4096
    ds_read_b64_tr_b16 v[146:147], v24 offset:6144
    ds_read_b64_tr_b16 v[148:149], v25 offset:4096
    ds_read_b64_tr_b16 v[150:151], v25 offset:6144
    v_exp_f32 v124, v72
    v_exp_f32 v125, v73
    v_exp_f32 v126, v74
    v_exp_f32 v127, v75
    v_add_f32 v15, v15, v124
    v_add_f32 v28, v28, v125
    ds_read_b64_tr_b16 v[152:153], v26 offset:4096
    ds_read_b64_tr_b16 v[154:155], v26 offset:6144
    ds_read_b64_tr_b16 v[156:157], v27 offset:4096
    ds_read_b64_tr_b16 v[158:159], v27 offset:6144
    v_cvt_pk_bf16_f32 v116, v124, v125
    v_exp_f32 v122, v76
    v_exp_f32 v123, v77
    v_add_f32 v15, v15, v126
    v_add_f32 v28, v28, v127
    v_cvt_pk_bf16_f32 v117, v126, v127
    v_exp_f32 v124, v78
    v_exp_f32 v125, v79
    v_add_f32 v15, v15, v122
    v_add_f32 v28, v28, v123
    v_cvt_pk_bf16_f32 v118, v122, v123
    v_add_f32 v15, v15, v124
    v_add_f32 v28, v28, v125
    v_cvt_pk_bf16_f32 v119, v124, v125
    v_add_f32 v15, v15, v28
    v_cmp_lt_f32 vcc, s32, v15
    s_nop 3
    s_cbranch_vccnz F_tr_h2
F_bk_h2:
    v_add_f32 v14, v14, v15
    buffer_load_dwordx4 v90, s[56:59], s33 offen offset:2048 lds
    buffer_load_dwordx4 v91, s[56:59], s33 offen offset:3072 lds
    s_add_u32 m0, s49, 131072
    s_add_u32 s33, s47, 131072
    buffer_load_dwordx4 v13, s[56:59], s33 offen offset:0 lds
    buffer_load_dwordx4 v89, s[56:59], s33 offen offset:1024 lds
    s_waitcnt lgkmcnt(0)
    s_setprio 1
    v_mfma_f32_32x32x16_bf16 v[192:207], v[128:131], v[112:115], v[192:207]
    v_mfma_f32_32x32x16_bf16 v[208:223], v[132:135], v[112:115], v[208:223]
    v_mfma_f32_32x32x16_bf16 v[224:239], v[136:139], v[112:115], v[224:239]
    v_mfma_f32_32x32x16_bf16 v[240:255], v[140:143], v[112:115], v[240:255]
    v_mfma_f32_32x32x16_bf16 v[192:207], v[144:147], v[116:119], v[192:207]
    v_mfma_f32_32x32x16_bf16 v[208:223], v[148:151], v[116:119], v[208:223]
    v_mfma_f32_32x32x16_bf16 v[224:239], v[152:155], v[116:119], v[224:239]
    v_mfma_f32_32x32x16_bf16 v[240:255], v[156:159], v[116:119], v[240:255]
    s_setprio 0
    s_mul_i32 s42, s31, 5120
    s_add_u32 s42, s42, 19456
    s_cmp_eq_u32 s31, 3
    s_cmov_b32 s42, 75776
    v_and_b32 v93, 15, v1
    v_lshrrev_b32 v94, 5, v1
    v_bfe_u32 v95, v1, 4, 1
    v_lshlrev_b32 v93, 4, v93
    v_lshl_add_u32 v93, v94, 8, v93
    v_lshl_add_u32 v93, v95, 10, v93
    v_add_u32 v93, s42, v93
    buffer_load_dwordx4 v90, s[56:59], s33 offen offset:2048 lds
    buffer_load_dwordx4 v91, s[56:59], s33 offen offset:3072 lds
    s_add_u32 m0, s49, 114688
    s_add_u32 s33, s48, 0
    buffer_load_dwordx4 v13, s[56:59], s33 offen offset:0 lds
    s_cmp_ge_u32 s31, 2
    s_cselect_b32 s39, 2, 0
    s_lshl_b32 s39, s39, 14
    s_sub_u32 s37, s39, s35
    s_mov_b32 s35, s39
    v_add_u32 v16, s37, v16
    v_add_u32 v17, s37, v17
    v_add_u32 v18, s37, v18
    v_add_u32 v19, s37, v19
    v_add_u32 v20, s37, v20
    v_add_u32 v21, s37, v21
    v_add_u32 v22, s37, v22
    v_add_u32 v23, s37, v23
    s_waitcnt vmcnt(13) lgkmcnt(0)
    s_barrier
    ds_read_b128 v[128:131], v16 offset:0
    ds_read_b128 v[132:135], v17 offset:0
    ds_read_b128 v[136:139], v18 offset:0
    ds_read_b128 v[140:143], v19 offset:0
    ds_read_b128 v[144:147], v20 offset:0
    ds_read_b128 v[148:151], v21 offset:0
    ds_read_b128 v[152:155], v22 offset:0
    ds_read_b128 v[156:159], v23 offset:0
    buffer_load_dwordx4 v89, s[56:59], s33 offen offset:1024 lds
    buffer_load_dwordx4 v90, s[56:59], s33 offen offset:2048 lds
    buffer_load_dwordx4 v91, s[56:59], s33 offen offset:3072 lds
    s_add_u32 m0, s49, 147456
    s_add_u32 s33, s48, 131072
    buffer_load_dwordx4 v13, s[56:59], s33 offen offset:0 lds
    s_waitcnt lgkmcnt(0)
    s_setprio 1
    v_mfma_f32_32x32x16_bf16 v[64:79], v[128:131], v[32:35], v[96:111]
    v_mfma_f32_32x32x16_bf16 v[64:79], v[132:135], v[36:39], v[64:79]
    v_mfma_f32_32x32x16_bf16 v[64:79], v[136:139], v[40:43], v[64:79]
    v_mfma_f32_32x32x16_bf16 v[64:79], v[140:143], v[44:47], v[64:79]
    v_mfma_f32_32x32x16_bf16 v[64:79], v[144:147], v[48:51], v[64:79]
    v_mfma_f32_32x32x16_bf16 v[64:79], v[148:151], v[52:55], v[64:79]
    v_mfma_f32_32x32x16_bf16 v[64:79], v[152:155], v[56:59], v[64:79]
    v_mfma_f32_32x32x16_bf16 v[64:79], v[156:159], v[60:63], v[64:79]
    s_setprio 0
    s_nop 11
    v_exp_f32 v122, v64
    v_exp_f32 v123, v65
    v_exp_f32 v124, v66
    v_exp_f32 v125, v67
    v_add_f32 v15, v122, v123
    v_cvt_pk_bf16_f32 v112, v122, v123
    v_exp_f32 v126, v68
    v_exp_f32 v127, v69
    v_add_f32 v28, v124, v125
    v_cvt_pk_bf16_f32 v113, v124, v125
    v_exp_f32 v122, v70
    v_exp_f32 v123, v71
    v_add_f32 v15, v15, v126
    v_add_f32 v28, v28, v127
    v_cvt_pk_bf16_f32 v114, v126, v127
    v_exp_f32 v124, v72
    v_exp_f32 v125, v73
    v_add_f32 v15, v15, v122
    v_add_f32 v28, v28, v123
    v_cvt_pk_bf16_f32 v115, v122, v123
    v_exp_f32 v126, v74
    v_exp_f32 v127, v75
    v_add_f32 v15, v15, v124
    v_add_f32 v28, v28, v125
    v_cvt_pk_bf16_f32 v116, v124, v125
    v_exp_f32 v122, v76
    v_exp_f32 v123, v77
    v_add_f32 v15, v15, v126
    v_add_f32 v28, v28, v127
    v_cvt_pk_bf16_f32 v117, v126, v127
    v_exp_f32 v124, v78
    v_exp_f32 v125, v79
    v_add_f32 v15, v15, v122
    v_add_f32 v28, v28, v123
    v_cvt_pk_bf16_f32 v118, v122, v123
    v_add_f32 v15, v15, v124
    v_add_f32 v28, v28, v125
    v_cvt_pk_bf16_f32 v119, v124, v125
    v_add_f32 v15, v15, v28
    v_cmp_lt_f32 vcc, s32, v15
    s_nop 3
    s_cbranch_vccnz F_tr_h3
F_bk_h3:
    v_add_f32 v14, v14, v15
    v_sub_f32 v15, 0, v96
    ds_write_b64 v8, v[14:15]
    buffer_load_dwordx4 v89, s[56:59], s33 offen offset:1024 lds
    buffer_load_dwordx4 v90, s[56:59], s33 offen offset:2048 lds
    buffer_load_dwordx4 v91, s[56:59], s33 offen offset:3072 lds
    s_cmp_ge_u32 s31, 2
    s_cselect_b32 s39, 1, 3
    s_lshl_b32 s39, s39, 14
    s_sub_u32 s37, s39, s36
    s_mov_b32 s36, s39
    v_add_u32 v24, s37, v24
    v_add_u32 v25, s37, v25
    v_add_u32 v26, s37, v26
    v_add_u32 v27, s37, v27
    s_waitcnt vmcnt(16) lgkmcnt(0)
    s_barrier
    ds_read_b64_tr_b16 v[128:129], v24 offset:0
    ds_read_b64_tr_b16 v[130:131], v24 offset:2048
    ds_read_b64_tr_b16 v[132:133], v25 offset:0
    ds_read_b64_tr_b16 v[134:135], v25 offset:2048
    ds_read_b64_tr_b16 v[136:137], v26 offset:0
    ds_read_b64_tr_b16 v[138:139], v26 offset:2048
    ds_read_b64_tr_b16 v[140:141], v27 offset:0
    ds_read_b64_tr_b16 v[142:143], v27 offset:2048
    ds_read_b64_tr_b16 v[144:145], v24 offset:4096
    ds_read_b64_tr_b16 v[146:147], v24 offset:6144
    ds_read_b64_tr_b16 v[148:149], v25 offset:4096
    ds_read_b64_tr_b16 v[150:151], v25 offset:6144
    s_waitcnt lgkmcnt(6)
    ds_read_b64_tr_b16 v[152:153], v26 offset:4096
    ds_read_b64_tr_b16 v[154:155], v26 offset:6144
    ds_read_b64_tr_b16 v[156:157], v27 offset:4096
    ds_read_b64_tr_b16 v[158:159], v27 offset:6144
    v_xor_b32 v7, 512, v8
    ds_read_b64 v[66:67], v7
    v_xor_b32 v7, 1024, v8
    ds_read_b64 v[68:69], v7
    v_xor_b32 v7, 1536, v8
    ds_read_b64 v[70:71], v7
    v_mov_b32 v64, v14
    v_mov_b32 v65, v15
    s_waitcnt lgkmcnt(0)
    s_setprio 1
    v_mfma_f32_32x32x16_bf16 v[208:223], v[132:135], v[112:115], v[208:223]
    v_mfma_f32_32x32x16_bf16 v[208:223], v[148:151], v[116:119], v[208:223]
    v_mfma_f32_32x32x16_bf16 v[224:239], v[136:139], v[112:115], v[224:239]
    v_mfma_f32_32x32x16_bf16 v[224:239], v[152:155], v[116:119], v[224:239]
    v_mfma_f32_32x32x16_bf16 v[240:255], v[140:143], v[112:115], v[240:255]
    v_mfma_f32_32x32x16_bf16 v[240:255], v[156:159], v[116:119], v[240:255]
    v_mfma_f32_32x32x16_bf16 v[192:207], v[128:131], v[112:115], v[192:207]
    v_mfma_f32_32x32x16_bf16 v[192:207], v[144:147], v[116:119], v[192:207]
    s_setprio 0
    s_nop 4
    ds_write_b128 v9, v[208:211] offset:0
    ds_write_b128 v9, v[212:215] offset:1024
    ds_write_b128 v9, v[216:219] offset:2048
    ds_write_b128 v9, v[220:223] offset:3072
    ds_write_b128 v0, v[224:227] offset:0
    ds_write_b128 v0, v[228:231] offset:1024
    ds_write_b128 v0, v[232:235] offset:2048
    ds_write_b128 v0, v[236:239] offset:3072
    ds_write_b128 v5, v[240:243] offset:0
    ds_write_b128 v5, v[244:247] offset:1024
    ds_write_b128 v5, v[248:251] offset:2048
    ds_write_b128 v5, v[252:255] offset:3072
    v_xor_b32 v9, 4096, v9
    v_xor_b32 v0, 8192, v0
    v_xor_b32 v5, 12288, v5
    v_max3_f32 v28, v65, v67, v69
    v_max_f32 v28, v28, v71
    v_sub_f32 v65, v65, v28
    v_sub_f32 v67, v67, v28
    v_sub_f32 v69, v69, v28
    v_sub_f32 v71, v71, v28
    v_exp_f32 v65, v65
    v_exp_f32 v67, v67
    v_exp_f32 v69, v69
    v_exp_f32 v71, v71
    s_nop 0
    v_mul_f32 v29, v64, v65
    v_fmac_f32 v29, v66, v67
    v_fmac_f32 v29, v68, v69
    v_fmac_f32 v29, v70, v71
    v_mov_b32 v30, v29
    s_nop 1
    v_permlane32_swap_b32 v29, v30
    v_add_f32 v29, v29, v30
    v_rcp_f32 v29, v29
    s_nop 0
    v_mul_f32 v65, v65, v29
    v_mul_f32 v67, v67, v29
    v_mul_f32 v69, v69, v29
    v_mul_f32 v71, v71, v29
    v_mul_f32 v192, v65, v192
    v_mul_f32 v193, v65, v193
    v_mul_f32 v194, v65, v194
    v_mul_f32 v195, v65, v195
    v_mul_f32 v196, v65, v196
    v_mul_f32 v197, v65, v197
    v_mul_f32 v198, v65, v198
    v_mul_f32 v199, v65, v199
    v_mul_f32 v200, v65, v200
    v_mul_f32 v201, v65, v201
    v_mul_f32 v202, v65, v202
    v_mul_f32 v203, v65, v203
    v_mul_f32 v204, v65, v204
    v_mul_f32 v205, v65, v205
    v_mul_f32 v206, v65, v206
    v_mul_f32 v207, v65, v207
    s_waitcnt lgkmcnt(0)
    s_barrier
    ds_read_b128 v[208:211], v9 offset:0
    ds_read_b128 v[212:215], v9 offset:1024
    ds_read_b128 v[216:219], v9 offset:2048
    ds_read_b128 v[220:223], v9 offset:3072
    ds_read_b128 v[224:227], v0 offset:0
    ds_read_b128 v[228:231], v0 offset:1024
    ds_read_b128 v[232:235], v0 offset:2048
    ds_read_b128 v[236:239], v0 offset:3072
    ds_read_b128 v[240:243], v5 offset:0
    ds_read_b128 v[244:247], v5 offset:1024
    ds_read_b128 v[248:251], v5 offset:2048
    ds_read_b128 v[252:255], v5 offset:3072
    s_mov_b64 exec, 0xff
    buffer_load_dword v24, v92, s[24:27], s51 offen sc1
    s_mov_b64 exec, -1
    s_waitcnt lgkmcnt(8)
    v_fmac_f32 v192, v67, v208
    v_fmac_f32 v193, v67, v209
    v_fmac_f32 v194, v67, v210
    v_fmac_f32 v195, v67, v211
    v_fmac_f32 v196, v67, v212
    v_fmac_f32 v197, v67, v213
    v_fmac_f32 v198, v67, v214
    v_fmac_f32 v199, v67, v215
    v_fmac_f32 v200, v67, v216
    v_fmac_f32 v201, v67, v217
    v_fmac_f32 v202, v67, v218
    v_fmac_f32 v203, v67, v219
    v_fmac_f32 v204, v67, v220
    v_fmac_f32 v205, v67, v221
    v_fmac_f32 v206, v67, v222
    v_fmac_f32 v207, v67, v223
    s_waitcnt lgkmcnt(4)
    v_fmac_f32 v192, v69, v224
    v_fmac_f32 v193, v69, v225
    v_fmac_f32 v194, v69, v226
    v_fmac_f32 v195, v69, v227
    v_fmac_f32 v196, v69, v228
    v_fmac_f32 v197, v69, v229
    v_fmac_f32 v198, v69, v230
    v_fmac_f32 v199, v69, v231
    v_fmac_f32 v200, v69, v232
    v_fmac_f32 v201, v69, v233
    v_fmac_f32 v202, v69, v234
    v_fmac_f32 v203, v69, v235
    v_fmac_f32 v204, v69, v236
    v_fmac_f32 v205, v69, v237
    v_fmac_f32 v206, v69, v238
    v_fmac_f32 v207, v69, v239
    s_waitcnt lgkmcnt(0)
    v_fmac_f32 v192, v71, v240
    v_fmac_f32 v193, v71, v241
    v_fmac_f32 v194, v71, v242
    v_fmac_f32 v195, v71, v243
    v_fmac_f32 v196, v71, v244
    v_fmac_f32 v197, v71, v245
    v_fmac_f32 v198, v71, v246
    v_fmac_f32 v199, v71, v247
    v_fmac_f32 v200, v71, v248
    v_fmac_f32 v201, v71, v249
    v_fmac_f32 v202, v71, v250
    v_fmac_f32 v203, v71, v251
    v_fmac_f32 v204, v71, v252
    v_fmac_f32 v205, v71, v253
    v_fmac_f32 v206, v71, v254
    v_fmac_f32 v207, v71, v255
    v_cvt_pk_bf16_f32 v128, v192, v193
    v_cvt_pk_bf16_f32 v129, v194, v195
    v_cvt_pk_bf16_f32 v130, v196, v197
    v_cvt_pk_bf16_f32 v131, v198, v199
    buffer_store_dwordx4 v[128:131], v2, s[24:27], s50 offen sc1
    ds_write_b128 v93, v[128:131] offset:0
    v_cvt_pk_bf16_f32 v132, v200, v201
    v_cvt_pk_bf16_f32 v133, v202, v203
    v_cvt_pk_bf16_f32 v134, v204, v205
    v_cvt_pk_bf16_f32 v135, v206, v207
    buffer_store_dwordx4 v[132:135], v3, s[24:27], s50 offen sc1
    ds_write_b128 v93, v[132:135] offset:512
    s_setprio 0
    s_waitcnt vmcnt(15) lgkmcnt(0)
    s_barrier
    s_waitcnt vmcnt(2)
    v_cmp_eq_u32 vcc, 1, v24
    s_nop 1
    s_mov_b32 s55, vcc_lo
    s_bitcmp1_b32 s55, 1
    s_cbranch_scc0 F_g0b
    s_mov_b64 exec, 0xff
    buffer_load_dword v24, v92, s[24:27], s51 offen sc1
    s_mov_b64 exec, -1
    s_bfe_u32 s35, s4, 196612
    s_add_u32 s35, s35, s5
    s_mul_i32 s35, s35, 8192
    s_mov_b32 m0, s10
    s_nop 0
    buffer_load_dwordx4 v160, s[24:27], s35 offen offset:0 sc1 lds
    buffer_load_dwordx4 v161, s[24:27], s35 offen offset:1024 sc1 lds
    buffer_load_dwordx4 v162, s[24:27], s35 offen offset:2048 sc1 lds
    buffer_load_dwordx4 v163, s[24:27], s35 offen offset:3072 sc1 lds
    s_add_u32 m0, s10, 4096
    s_nop 0
    buffer_load_dwordx4 v164, s[24:27], s35 offen offset:0 sc1 lds
    s_bfe_u32 s35, s4, 196612
    s_add_u32 s35, s35, s5
    s_mul_i32 s35, s35, 8192
    s_add_u32 s35, s35, 4096
    s_mov_b32 m0, s11
    s_nop 0
    buffer_load_dwordx4 v160, s[24:27], s35 offen offset:0 sc1 lds
    buffer_load_dwordx4 v161, s[24:27], s35 offen offset:1024 sc1 lds
    buffer_load_dwordx4 v162, s[24:27], s35 offen offset:2048 sc1 lds
    buffer_load_dwordx4 v163, s[24:27], s35 offen offset:3072 sc1 lds
    s_add_u32 m0, s11, 4096
    s_nop 0
    buffer_load_dwordx4 v164, s[24:27], s35 offen offset:0 sc1 lds
    s_waitcnt vmcnt(11)
    s_branch F_g0c
F_g0b:
    s_waitcnt vmcnt(0)
F_g0c:
    s_barrier
    s_bitcmp1_b32 s55, 1
    s_cbranch_scc1 F_g1c
    s_branch F_gs1
F_gb1:
    s_mov_b64 exec, 0xff
    buffer_load_dword v24, v92, s[24:27], s51 offen sc1
    s_mov_b64 exec, -1
    s_bfe_u32 s35, s4, 196612
    s_add_u32 s35, s35, s5
    s_mul_i32 s35, s35, 8192
    s_mov_b32 m0, s10
    s_nop 0
    buffer_load_dwordx4 v160, s[24:27], s35 offen offset:0 sc1 lds
    buffer_load_dwordx4 v161, s[24:27], s35 offen offset:1024 sc1 lds
    buffer_load_dwordx4 v162, s[24:27], s35 offen offset:2048 sc1 lds
    buffer_load_dwordx4 v163, s[24:27], s35 offen offset:3072 sc1 lds
    s_add_u32 m0, s10, 4096
    s_nop 0
    buffer_load_dwordx4 v164, s[24:27], s35 offen offset:0 sc1 lds
    s_bfe_u32 s35, s4, 196612
    s_add_u32 s35, s35, s5
    s_mul_i32 s35, s35, 8192
    s_add_u32 s35, s35, 4096
    s_mov_b32 m0, s11
    s_nop 0
    buffer_load_dwordx4 v160, s[24:27], s35 offen offset:0 sc1 lds
    buffer_load_dwordx4 v161, s[24:27], s35 offen offset:1024 sc1 lds
    buffer_load_dwordx4 v162, s[24:27], s35 offen offset:2048 sc1 lds
    buffer_load_dwordx4 v163, s[24:27], s35 offen offset:3072 sc1 lds
    s_add_u32 m0, s11, 4096
    s_nop 0
    buffer_load_dwordx4 v164, s[24:27], s35 offen offset:0 sc1 lds
F_g1c:
    s_bfe_u32 s33, s4, 196616
    s_add_u32 s33, s33, s5
    s_lshl_b32 s33, s33, 18
    s_add_u32 m0, s49, 98304
    s_nop 0
    buffer_load_dwordx4 v13, s[56:59], s33 offen offset:0 lds
    buffer_load_dwordx4 v89, s[56:59], s33 offen offset:1024 lds
    buffer_load_dwordx4 v90, s[56:59], s33 offen offset:2048 lds
    buffer_load_dwordx4 v91, s[56:59], s33 offen offset:3072 lds
    s_waitcnt vmcnt(9)
    s_barrier
    v_cmp_eq_u32 vcc, 1, v24
    s_nop 1
    s_mov_b32 s55, vcc_lo
    s_bitcmp1_b32 s55, 2
    s_cbranch_scc0 F_gs2
F_gb2:
    s_mov_b64 exec, 0xff
    buffer_load_dword v24, v92, s[24:27], s51 offen sc1
    s_mov_b64 exec, -1
    s_bfe_u32 s35, s4, 196616
    s_add_u32 s35, s35, s5
    s_mul_i32 s35, s35, 8192
    s_mov_b32 m0, s8
    s_nop 0
    buffer_load_dwordx4 v160, s[24:27], s35 offen offset:0 sc1 lds
    buffer_load_dwordx4 v161, s[24:27], s35 offen offset:1024 sc1 lds
    buffer_load_dwordx4 v162, s[24:27], s35 offen offset:2048 sc1 lds
    buffer_load_dwordx4 v163, s[24:27], s35 offen offset:3072 sc1 lds
    s_add_u32 m0, s8, 4096
    s_nop 0
    buffer_load_dwordx4 v164, s[24:27], s35 offen offset:0 sc1 lds
    s_bfe_u32 s33, s4, 196616
    s_add_u32 s33, s33, s5
    s_lshl_b32 s33, s33, 18
    s_add_u32 s33, s33, 131072
    s_add_u32 m0, s49, 131072
    s_nop 0
    buffer_load_dwordx4 v13, s[56:59], s33 offen offset:0 lds
    buffer_load_dwordx4 v89, s[56:59], s33 offen offset:1024 lds
    buffer_load_dwordx4 v90, s[56:59], s33 offen offset:2048 lds
    buffer_load_dwordx4 v91, s[56:59], s33 offen offset:3072 lds
    s_waitcnt vmcnt(14)
    s_barrier
    s_bfe_u32 s35, s4, 196616
    s_add_u32 s35, s35, s5
    s_mul_i32 s35, s35, 8192
    s_add_u32 s35, s35, 4096
    s_mov_b32 m0, s9
    s_nop 0
    buffer_load_dwordx4 v160, s[24:27], s35 offen offset:0 sc1 lds
    buffer_load_dwordx4 v161, s[24:27], s35 offen offset:1024 sc1 lds
    buffer_load_dwordx4 v162, s[24:27], s35 offen offset:2048 sc1 lds
    buffer_load_dwordx4 v163, s[24:27], s35 offen offset:3072 sc1 lds
    s_add_u32 m0, s9, 4096
    s_nop 0
    buffer_load_dwordx4 v164, s[24:27], s35 offen offset:0 sc1 lds
    s_bfe_u32 s33, s4, 196620
    s_add_u32 s33, s33, s5
    s_lshl_b32 s33, s33, 18
    s_add_u32 m0, s49, 114688
    s_nop 0
    buffer_load_dwordx4 v13, s[56:59], s33 offen offset:0 lds
    buffer_load_dwordx4 v89, s[56:59], s33 offen offset:1024 lds
    buffer_load_dwordx4 v90, s[56:59], s33 offen offset:2048 lds
    buffer_load_dwordx4 v91, s[56:59], s33 offen offset:3072 lds
    s_waitcnt vmcnt(13)
    s_barrier
    v_cmp_eq_u32 vcc, 1, v24
    s_nop 1
    s_mov_b32 s55, vcc_lo
    s_bitcmp1_b32 s55, 3
    s_cbranch_scc0 F_gs3
F_gb3:
    s_mov_b64 exec, 0xff
    buffer_load_dword v24, v92, s[24:27], s51 offen sc1
    s_mov_b64 exec, -1
    s_bfe_u32 s35, s4, 196620
    s_add_u32 s35, s35, s5
    s_mul_i32 s35, s35, 8192
    s_mov_b32 m0, s10
    s_nop 0
    buffer_load_dwordx4 v160, s[24:27], s35 offen offset:0 sc1 lds
    buffer_load_dwordx4 v161, s[24:27], s35 offen offset:1024 sc1 lds
    buffer_load_dwordx4 v162, s[24:27], s35 offen offset:2048 sc1 lds
    buffer_load_dwordx4 v163, s[24:27], s35 offen offset:3072 sc1 lds
    s_add_u32 m0, s10, 4096
    s_nop 0
    buffer_load_dwordx4 v164, s[24:27], s35 offen offset:0 sc1 lds
    s_bfe_u32 s33, s4, 196620
    s_add_u32 s33, s33, s5
    s_lshl_b32 s33, s33, 18
    s_add_u32 s33, s33, 131072
    s_add_u32 m0, s49, 147456
    s_nop 0
    buffer_load_dwordx4 v13, s[56:59], s33 offen offset:0 lds
    buffer_load_dwordx4 v89, s[56:59], s33 offen offset:1024 lds
    buffer_load_dwordx4 v90, s[56:59], s33 offen offset:2048 lds
    buffer_load_dwordx4 v91, s[56:59], s33 offen offset:3072 lds
    s_waitcnt vmcnt(14)
    s_barrier
    s_bfe_u32 s35, s4, 196620
    s_add_u32 s35, s35, s5
    s_mul_i32 s35, s35, 8192
    s_add_u32 s35, s35, 4096
    s_mov_b32 m0, s11
    s_nop 0
    buffer_load_dwordx4 v160, s[24:27], s35 offen offset:0 sc1 lds
    buffer_load_dwordx4 v161, s[24:27], s35 offen offset:1024 sc1 lds
    buffer_load_dwordx4 v162, s[24:27], s35 offen offset:2048 sc1 lds
    buffer_load_dwordx4 v163, s[24:27], s35 offen offset:3072 sc1 lds
    s_add_u32 m0, s11, 4096
    s_nop 0
    buffer_load_dwordx4 v164, s[24:27], s35 offen offset:0 sc1 lds
    s_bfe_u32 s33, s4, 196624
    s_add_u32 s33, s33, s5
    s_lshl_b32 s33, s33, 18
    s_add_u32 m0, s49, 98304
    s_nop 0
    buffer_load_dwordx4 v13, s[56:59], s33 offen offset:0 lds
    buffer_load_dwordx4 v89, s[56:59], s33 offen offset:1024 lds
    buffer_load_dwordx4 v90, s[56:59], s33 offen offset:2048 lds
    buffer_load_dwordx4 v91, s[56:59], s33 offen offset:3072 lds
    s_waitcnt vmcnt(13)
    s_barrier
    v_cmp_eq_u32 vcc, 1, v24
    s_nop 1
    s_mov_b32 s55, vcc_lo
    s_bitcmp1_b32 s55, 4
    s_cbranch_scc0 F_gs4
F_gb4:
    s_bfe_u32 s35, s4, 196624
    s_add_u32 s35, s35, s5
    s_mul_i32 s35, s35, 8192
    s_mov_b32 m0, s8
    s_nop 0
    buffer_load_dwordx4 v160, s[24:27], s35 offen offset:0 sc1 lds
    buffer_load_dwordx4 v161, s[24:27], s35 offen offset:1024 sc1 lds
    buffer_load_dwordx4 v162, s[24:27], s35 offen offset:2048 sc1 lds
    buffer_load_dwordx4 v163, s[24:27], s35 offen offset:3072 sc1 lds
    s_add_u32 m0, s8, 4096
    s_nop 0
    buffer_load_dwordx4 v164, s[24:27], s35 offen offset:0 sc1 lds
    s_bfe_u32 s33, s4, 196624
    s_add_u32 s33, s33, s5
    s_lshl_b32 s33, s33, 18
    s_add_u32 s33, s33, 131072
    s_add_u32 m0, s49, 131072
    s_nop 0
    buffer_load_dwordx4 v13, s[56:59], s33 offen offset:0 lds
    buffer_load_dwordx4 v89, s[56:59], s33 offen offset:1024 lds
    buffer_load_dwordx4 v90, s[56:59], s33 offen offset:2048 lds
    buffer_load_dwordx4 v91, s[56:59], s33 offen offset:3072 lds
    s_waitcnt vmcnt(13)
    s_barrier
    s_bfe_u32 s35, s4, 196624
    s_add_u32 s35, s35, s5
    s_mul_i32 s35, s35, 8192
    s_add_u32 s35, s35, 4096
    s_mov_b32 m0, s9
    s_nop 0
    buffer_load_dwordx4 v160, s[24:27], s35 offen offset:0 sc1 lds
    buffer_load_dwordx4 v161, s[24:27], s35 offen offset:1024 sc1 lds
    buffer_load_dwordx4 v162, s[24:27], s35 offen offset:2048 sc1 lds
    buffer_load_dwordx4 v163, s[24:27], s35 offen offset:3072 sc1 lds
    s_add_u32 m0, s9, 4096
    s_nop 0
    buffer_load_dwordx4 v164, s[24:27], s35 offen offset:0 sc1 lds
    s_bfe_u32 s33, s4, 196628
    s_add_u32 s33, s33, s5
    s_lshl_b32 s33, s33, 18
    s_add_u32 m0, s49, 114688
    s_nop 0
    buffer_load_dwordx4 v13, s[56:59], s33 offen offset:0 lds
    buffer_load_dwordx4 v89, s[56:59], s33 offen offset:1024 lds
    buffer_load_dwordx4 v90, s[56:59], s33 offen offset:2048 lds
    buffer_load_dwordx4 v91, s[56:59], s33 offen offset:3072 lds
    s_waitcnt vmcnt(13)
    s_barrier
    s_bitcmp1_b32 s55, 5
    s_cbranch_scc0 F_gs5
F_gb5:
    s_bfe_u32 s35, s4, 196628
    s_add_u32 s35, s35, s5
    s_mul_i32 s35, s35, 8192
    s_mov_b32 m0, s10
    s_nop 0
    buffer_load_dwordx4 v160, s[24:27], s35 offen offset:0 sc1 lds
    buffer_load_dwordx4 v161, s[24:27], s35 offen offset:1024 sc1 lds
    buffer_load_dwordx4 v162, s[24:27], s35 offen offset:2048 sc1 lds
    buffer_load_dwordx4 v163, s[24:27], s35 offen offset:3072 sc1 lds
    s_add_u32 m0, s10, 4096
    s_nop 0
    buffer_load_dwordx4 v164, s[24:27], s35 offen offset:0 sc1 lds
    s_bfe_u32 s33, s4, 196628
    s_add_u32 s33, s33, s5
    s_lshl_b32 s33, s33, 18
    s_add_u32 s33, s33, 131072
    s_add_u32 m0, s49, 147456
    s_nop 0
    buffer_load_dwordx4 v13, s[56:59], s33 offen offset:0 lds
    buffer_load_dwordx4 v89, s[56:59], s33 offen offset:1024 lds
    buffer_load_dwordx4 v90, s[56:59], s33 offen offset:2048 lds
    buffer_load_dwordx4 v91, s[56:59], s33 offen offset:3072 lds
    s_waitcnt vmcnt(13)
    s_barrier
    s_bfe_u32 s35, s4, 196628
    s_add_u32 s35, s35, s5
    s_mul_i32 s35, s35, 8192
    s_add_u32 s35, s35, 4096
    s_mov_b32 m0, s11
    s_nop 0
    buffer_load_dwordx4 v160, s[24:27], s35 offen offset:0 sc1 lds
    buffer_load_dwordx4 v161, s[24:27], s35 offen offset:1024 sc1 lds
    buffer_load_dwordx4 v162, s[24:27], s35 offen offset:2048 sc1 lds
    buffer_load_dwordx4 v163, s[24:27], s35 offen offset:3072 sc1 lds
    s_add_u32 m0, s11, 4096
    s_nop 0
    buffer_load_dwordx4 v164, s[24:27], s35 offen offset:0 sc1 lds
    s_bfe_u32 s33, s4, 196632
    s_add_u32 s33, s33, s5
    s_lshl_b32 s33, s33, 18
    s_add_u32 m0, s49, 98304
    s_nop 0
    buffer_load_dwordx4 v13, s[56:59], s33 offen offset:0 lds
    buffer_load_dwordx4 v89, s[56:59], s33 offen offset:1024 lds
    buffer_load_dwordx4 v90, s[56:59], s33 offen offset:2048 lds
    buffer_load_dwordx4 v91, s[56:59], s33 offen offset:3072 lds
    s_waitcnt vmcnt(13)
    s_barrier
    s_bitcmp1_b32 s55, 6
    s_cbranch_scc0 F_gs6
F_gb6:
    s_bfe_u32 s35, s4, 196632
    s_add_u32 s35, s35, s5
    s_mul_i32 s35, s35, 8192
    s_mov_b32 m0, s8
    s_nop 0
    buffer_load_dwordx4 v160, s[24:27], s35 offen offset:0 sc1 lds
    buffer_load_dwordx4 v161, s[24:27], s35 offen offset:1024 sc1 lds
    buffer_load_dwordx4 v162, s[24:27], s35 offen offset:2048 sc1 lds
    buffer_load_dwordx4 v163, s[24:27], s35 offen offset:3072 sc1 lds
    s_add_u32 m0, s8, 4096
    s_nop 0
    buffer_load_dwordx4 v164, s[24:27], s35 offen offset:0 sc1 lds
    s_bfe_u32 s33, s4, 196632
    s_add_u32 s33, s33, s5
    s_lshl_b32 s33, s33, 18
    s_add_u32 s33, s33, 131072
    s_add_u32 m0, s49, 131072
    s_nop 0
    buffer_load_dwordx4 v13, s[56:59], s33 offen offset:0 lds
    buffer_load_dwordx4 v89, s[56:59], s33 offen offset:1024 lds
    buffer_load_dwordx4 v90, s[56:59], s33 offen offset:2048 lds
    buffer_load_dwordx4 v91, s[56:59], s33 offen offset:3072 lds
    s_waitcnt vmcnt(13)
    s_barrier
    s_bfe_u32 s35, s4, 196632
    s_add_u32 s35, s35, s5
    s_mul_i32 s35, s35, 8192
    s_add_u32 s35, s35, 4096
    s_mov_b32 m0, s9
    s_nop 0
    buffer_load_dwordx4 v160, s[24:27], s35 offen offset:0 sc1 lds
    buffer_load_dwordx4 v161, s[24:27], s35 offen offset:1024 sc1 lds
    buffer_load_dwordx4 v162, s[24:27], s35 offen offset:2048 sc1 lds
    buffer_load_dwordx4 v163, s[24:27], s35 offen offset:3072 sc1 lds
    s_add_u32 m0, s9, 4096
    s_nop 0
    buffer_load_dwordx4 v164, s[24:27], s35 offen offset:0 sc1 lds
    s_bfe_u32 s33, s4, 196636
    s_add_u32 s33, s33, s5
    s_lshl_b32 s33, s33, 18
    s_add_u32 m0, s49, 114688
    s_nop 0
    buffer_load_dwordx4 v13, s[56:59], s33 offen offset:0 lds
    buffer_load_dwordx4 v89, s[56:59], s33 offen offset:1024 lds
    buffer_load_dwordx4 v90, s[56:59], s33 offen offset:2048 lds
    buffer_load_dwordx4 v91, s[56:59], s33 offen offset:3072 lds
    s_waitcnt vmcnt(13)
    s_barrier
    s_bitcmp1_b32 s55, 7
    s_cbranch_scc0 F_gs7
F_gb7:
    s_bfe_u32 s35, s4, 196636
    s_add_u32 s35, s35, s5
    s_mul_i32 s35, s35, 8192
    s_mov_b32 m0, s10
    s_nop 0
    buffer_load_dwordx4 v160, s[24:27], s35 offen offset:0 sc1 lds
    buffer_load_dwordx4 v161, s[24:27], s35 offen offset:1024 sc1 lds
    buffer_load_dwordx4 v162, s[24:27], s35 offen offset:2048 sc1 lds
    buffer_load_dwordx4 v163, s[24:27], s35 offen offset:3072 sc1 lds
    s_add_u32 m0, s10, 4096
    s_nop 0
    buffer_load_dwordx4 v164, s[24:27], s35 offen offset:0 sc1 lds
    s_bfe_u32 s33, s4, 196636
    s_add_u32 s33, s33, s5
    s_lshl_b32 s33, s33, 18
    s_add_u32 s33, s33, 131072
    s_add_u32 m0, s49, 147456
    s_nop 0
    buffer_load_dwordx4 v13, s[56:59], s33 offen offset:0 lds
    buffer_load_dwordx4 v89, s[56:59], s33 offen offset:1024 lds
    buffer_load_dwordx4 v90, s[56:59], s33 offen offset:2048 lds
    buffer_load_dwordx4 v91, s[56:59], s33 offen offset:3072 lds
    s_waitcnt vmcnt(13)
    s_barrier
    s_bfe_u32 s35, s4, 196636
    s_add_u32 s35, s35, s5
    s_mul_i32 s35, s35, 8192
    s_add_u32 s35, s35, 4096
    s_mov_b32 m0, s11
    s_nop 0
    buffer_load_dwordx4 v160, s[24:27], s35 offen offset:0 sc1 lds
    buffer_load_dwordx4 v161, s[24:27], s35 offen offset:1024 sc1 lds
    buffer_load_dwordx4 v162, s[24:27], s35 offen offset:2048 sc1 lds
    buffer_load_dwordx4 v163, s[24:27], s35 offen offset:3072 sc1 lds
    s_add_u32 m0, s11, 4096
    s_nop 0
    buffer_load_dwordx4 v164, s[24:27], s35 offen offset:0 sc1 lds
    s_waitcnt vmcnt(9)
    s_barrier
    s_waitcnt vmcnt(0)
    s_barrier
F_fin:
F_end:
    s_endpgm
F_gs1:
    s_mov_b32 s38, 0
    s_mov_b64 exec, 2
F_gl1:
    buffer_load_dword v25, v92, s[24:27], s51 offen sc1
    s_waitcnt vmcnt(0)
    v_cmp_ne_u32 vcc, 1, v25
    s_add_u32 s38, s38, 1
    s_cmp_gt_u32 s38, 2000000
    s_cbranch_scc1 F_gx1
    s_cbranch_vccnz F_gl1
F_gx1:
    s_mov_b64 exec, -1
    s_branch F_gb1
F_gs2:
    s_mov_b32 s38, 0
    s_mov_b64 exec, 4
F_gl2:
    buffer_load_dword v25, v92, s[24:27], s51 offen sc1
    s_waitcnt vmcnt(0)
    v_cmp_ne_u32 vcc, 1, v25
    s_add_u32 s38, s38, 1
    s_cmp_gt_u32 s38, 2000000
    s_cbranch_scc1 F_gx2
    s_cbranch_vccnz F_gl2
F_gx2:
    s_mov_b64 exec, -1
    s_branch F_gb2
F_gs3:
    s_mov_b32 s38, 0
    s_mov_b64 exec, 8
F_gl3:
    buffer_load_dword v25, v92, s[24:27], s51 offen sc1
    s_waitcnt vmcnt(0)
    v_cmp_ne_u32 vcc, 1, v25
    s_add_u32 s38, s38, 1
    s_cmp_gt_u32 s38, 2000000
    s_cbranch_scc1 F_gx3
    s_cbranch_vccnz F_gl3
F_gx3:
    s_mov_b64 exec, -1
    s_branch F_gb3
F_gs4:
    s_mov_b32 s38, 0
    s_mov_b64 exec, 16
F_gl4:
    buffer_load_dword v25, v92, s[24:27], s51 offen sc1
    s_waitcnt vmcnt(0)
    v_cmp_ne_u32 vcc, 1, v25
    s_add_u32 s38, s38, 1
    s_cmp_gt_u32 s38, 2000000
    s_cbranch_scc1 F_gx4
    s_cbranch_vccnz F_gl4
F_gx4:
    s_mov_b64 exec, -1
    s_branch F_gb4
F_gs5:
    s_mov_b32 s38, 0
    s_mov_b64 exec, 32
F_gl5:
    buffer_load_dword v25, v92, s[24:27], s51 offen sc1
    s_waitcnt vmcnt(0)
    v_cmp_ne_u32 vcc, 1, v25
    s_add_u32 s38, s38, 1
    s_cmp_gt_u32 s38, 2000000
    s_cbranch_scc1 F_gx5
    s_cbranch_vccnz F_gl5
F_gx5:
    s_mov_b64 exec, -1
    s_branch F_gb5
F_gs6:
    s_mov_b32 s38, 0
    s_mov_b64 exec, 64
F_gl6:
    buffer_load_dword v25, v92, s[24:27], s51 offen sc1
    s_waitcnt vmcnt(0)
    v_cmp_ne_u32 vcc, 1, v25
    s_add_u32 s38, s38, 1
    s_cmp_gt_u32 s38, 2000000
    s_cbranch_scc1 F_gx6
    s_cbranch_vccnz F_gl6
F_gx6:
    s_mov_b64 exec, -1
    s_branch F_gb6
F_gs7:
    s_mov_b32 s38, 0
    s_mov_b64 exec, 0x80
F_gl7:
    buffer_load_dword v25, v92, s[24:27], s51 offen sc1
    s_waitcnt vmcnt(0)
    v_cmp_ne_u32 vcc, 1, v25
    s_add_u32 s38, s38, 1
    s_cmp_gt_u32 s38, 2000000
    s_cbranch_scc1 F_gx7
    s_cbranch_vccnz F_gl7
F_gx7:
    s_mov_b64 exec, -1
    s_branch F_gb7
.p2align 12
.fill 608, 4, 0xbf800000
F_main:
    s_waitcnt lgkmcnt(0)
    s_mov_b32 s8, s36
    s_mov_b32 s9, s37
    s_mov_b32 s10, 2621440
    s_mov_b32 s11, 0x20000
    s_mov_b32 s20, s42
    s_mov_b32 s21, s43
    s_mov_b32 s22, 8388608
    s_mov_b32 s23, 0x20000
    s_mov_b32 s12, s38
    s_mov_b32 s13, s39
    s_mov_b32 s14, 33554432
    s_mov_b32 s15, 0x20000
    s_mov_b32 s16, s40
    s_mov_b32 s17, s41
    s_mov_b32 s18, 33554432
    s_mov_b32 s19, 0x20000
    s_mov_b32 s56, s44
    s_mov_b32 s57, s45
    s_mov_b32 s58, 8388608
    s_mov_b32 s59, 0x20000
    s_mov_b32 s60, s48
    s_mov_b32 s61, s49
    s_mov_b32 s62, 256
    s_mov_b32 s63, 0x20000
    s_mov_b32 s24, s50
    s_mov_b32 s25, s51
    s_mov_b32 s26, 28311552
    s_mov_b32 s27, 0x20000
    s_cmp_lg_u32 s28, 1
    s_cbranch_scc1 F_m2
    s_getpc_b64 s[40:41]
F_pc:
    s_sub_u32 s40, s40, F_pc-F_begin
    s_subb_u32 s41, s41, 0
    s_lshr_b32 s42, s2, 3
    s_mul_i32 s42, s42, 1920
    v_and_b32 v6, 15, v1
    v_lshlrev_b32 v6, 7, v6
    v_add_u32 v6, s42, v6
    s_mov_b32 s42, F_last-F_begin
    v_min_u32 v6, s42, v6
    global_load_dword v184, v6, s[40:41]
F_m2:
    s_cmp_lg_u32 s28, 2
    s_cbranch_scc1 F_t3
    s_call_b64 s[40:41], F_isl3
F_t3:
    s_cmp_lg_u32 s28, 3
    s_cbranch_scc1 F_t10
    s_call_b64 s[40:41], F_isl10
F_t10:
    s_and_b32 s42, s28, 1
    s_lshr_b32 s43, s28, 1
    s_mul_i32 s44, s43, 10240
    s_add_u32 s44, s44, 49152
    v_lshrrev_b32 v6, 1, v3
    v_xor_b32 v6, v6, v2
    v_lshlrev_b32 v6, 4, v6
    v_lshl_add_u32 v6, v3, 7, v6
    v_add_u32 v8, s44, v6
    v_xor_b32 v6, 64, v6
    v_add_u32 v9, s44, v6
    v_and_b32 v6, 1, v2
    v_lshl_or_b32 v6, v6, 2, v4
    s_lshl_b32 s45, s42, 2
    v_xor_b32 v6, s45, v6
    v_lshlrev_b32 v6, 5, v6
    v_lshl_add_u32 v7, v2, 3, v4
    v_lshl_add_u32 v6, v7, 8, v6
    v_lshl_add_u32 v6, v5, 3, v6
    v_xor_b32 v7, 0, v6
    v_add_u32 v10, 69632, v7
    v_xor_b32 v7, 32, v6
    v_add_u32 v11, 69632, v7
    v_xor_b32 v7, 64, v6
    v_add_u32 v12, 69632, v7
    v_xor_b32 v7, 96, v6
    v_add_u32 v13, 69632, v7
    v_and_b32 v6, 31, v1
    v_lshlrev_b32 v6, 8, v6
    v_lshrrev_b32 v7, 5, v1
    v_xor_b32 v7, v7, v3
    v_lshl_add_u32 v6, v7, 4, v6
    v_xor_b32 v16, 0, v6
    v_xor_b32 v17, 32, v6
    v_xor_b32 v18, 64, v6
    v_xor_b32 v19, 96, v6
    v_xor_b32 v20, 128, v6
    v_xor_b32 v21, 160, v6
    v_xor_b32 v22, 192, v6
    v_xor_b32 v23, 224, v6
    v_lshrrev_b32 v6, 5, v1
    v_lshl_add_u32 v6, v6, 2, v4
    v_lshlrev_b32 v6, 8, v6
    v_lshl_add_u32 v6, v4, 6, v6
    v_and_b32 v7, 1, v2
    v_lshl_add_u32 v6, v7, 5, v6
    v_lshl_add_u32 v6, v5, 3, v6
    v_xor_b32 v24, 0, v6
    v_xor_b32 v25, 64, v6
    v_xor_b32 v26, 128, v6
    v_xor_b32 v27, 192, v6
    s_mov_b32 s49, 0x3e0293ee
    s_lshl_b32 s44, s42, 12
    s_mul_i32 s45, s43, 16640
    s_add_u32 s45, s45, s44
    s_add_u32 s45, s45, 49152
    s_mul_i32 s37, s43, 24320
    s_add_u32 s37, s37, s44
    s_add_u32 s37, s37, 49408
    v_lshrrev_b32 v6, 1, v2
    v_lshlrev_b32 v6, 9, v6
    v_lshl_add_u32 v6, v3, 4, v6
    v_and_b32 v7, 1, v2
    v_lshl_add_u32 v6, v7, 3, v6
    v_add_u32 v187, s37, v6
    v_add_u32 v186, s45, v6
    s_lshl_b32 s44, s28, 13
    s_add_u32 s44, s44, 49152
    v_lshlrev_b32 v6, 4, v1
    v_add_u32 v188, s44, v6
    v_mov_b32 v14, 0
    v_add_u32 v24, 16384, v24
    v_add_u32 v25, 16384, v25
    v_add_u32 v26, 16384, v26
    v_add_u32 v27, 16384, v27
    s_mul_i32 s50, s29, 5
    s_add_u32 s50, s50, s28
    s_mul_i32 s50, s50, 263168
    s_mul_i32 s44, s30, 8192
    s_add_u32 s50, s50, s44
    s_add_u32 s50, s50, 8192
    s_and_b32 s18, s54, 1
    s_lshl_b32 s37, s42, 1
    s_add_u32 s18, s18, s37
    s_lshl_b32 s48, s29, 2
    s_add_u32 s48, s48, s54
    s_lshl_b32 s48, s48, 10
    s_add_u32 s48, s48, 16777216
    s_lshl_b32 s37, s52, 7
    s_add_u32 s48, s48, s37
    s_mov_b32 s23, s28
    s_lshl_b32 s16, s29, 3
    s_add_u32 s16, s16, s53
    s_mul_i32 s16, s16, 163840
    s_add_u32 s16, s16, 17825792
    s_mul_i32 s37, s28, 10240
    s_add_u32 s16, s16, s37
    s_and_b32 s44, s54, 1
    s_xor_b32 s45, s44, 1
    s_mul_i32 s37, s45, 5120
    s_add_u32 s17, s16, s37
    s_mul_i32 s37, s44, 5120
    s_add_u32 s16, s16, s37
    s_xor_b32 s37, s54, 1
    s_mul_i32 s37, s37, 40960
    s_add_u32 s12, s16, s37
    s_xor_b32 s37, s54, 2
    s_mul_i32 s37, s37, 40960
    s_add_u32 s13, s16, s37
    s_xor_b32 s37, s54, 3
    s_mul_i32 s37, s37, 40960
    s_add_u32 s14, s16, s37
    s_mul_i32 s37, s54, 40960
    s_add_u32 s16, s16, s37
    s_add_u32 s17, s17, s37
    s_lshr_b32 s55, s54, 1
    s_xor_b32 s55, s55, s42
    s_lshl_b32 s15, s29, 3
    s_add_u32 s15, s15, s53
    s_lshl_b32 s15, s15, 11
    s_add_u32 s15, s15, 16842752
    s_lshl_b32 s37, s28, 7
    s_add_u32 s15, s15, s37
    s_lshl_b32 s37, s54, 9
    s_add_u32 s36, s15, s37
    s_mul_i32 s47, s29, 327680
    s_lshl_b32 s37, s53, 8
    s_add_u32 s47, s47, s37
    s_lshl_b32 s37, s18, 6
    s_add_u32 s47, s47, s37
    s_mul_i32 s37, s43, 163840
    s_add_u32 s47, s47, s37
    s_load_dwordx2 s[40:41], s[0:1], 40
    s_waitcnt lgkmcnt(0)
    s_mov_b32 s8, s40
    s_mov_b32 s9, s41
    s_mov_b32 s10, 2621440
    s_mov_b32 s11, 0x20000
    s_mov_b32 s19, 49152
    s_cmp_eq_u32 s43, 1
    s_cmov_b32 s19, 16384
    s_mov_b32 s20, 67584
    s_cmp_eq_u32 s43, 1
    s_cmov_b32 s20, 72704
    s_mov_b32 s21, 0
    s_cmp_eq_u32 s43, 1
    s_cmov_b32 s21, 32768
    s_mov_b32 s22, 83968
    s_cmp_eq_u32 s43, 1
    s_cmov_b32 s22, 89088
    s_mov_b32 s33, 49152
    s_mov_b32 s34, 1024
    s_cmp_eq_u32 s28, 1
    s_cmov_b32 s33, 51200
    s_cmov_b32 s34, 1024
    s_cmp_eq_u32 s28, 2
    s_cmov_b32 s33, 53248
    s_cmov_b32 s34, 4294930432
    s_cmp_eq_u32 s28, 3
    s_cmov_b32 s33, 17408
    s_cmov_b32 s34, 1024
    s_lshl_b32 s35, s28, 11
    s_add_u32 s35, s35, 67584
    s_mov_b32 s44, 0
    s_mov_b32 s38, 14
    s_barrier
    ds_read_b64_tr_b16 v[32:33], v10 offset:0
    ds_read_b64_tr_b16 v[34:35], v10 offset:1024
    ds_read_b128 v[48:51], v8 offset:0
    ds_read_b128 v[52:55], v8 offset:2048
    ds_read_b64_tr_b16 v[36:37], v11 offset:0
    ds_read_b64_tr_b16 v[38:39], v11 offset:1024
    ds_read_b128 v[56:59], v8 offset:4096
    ds_read_b64_tr_b16 v[40:41], v12 offset:0
    ds_read_b64_tr_b16 v[42:43], v12 offset:1024
    ds_read_b128 v[60:63], v8 offset:6144
    ds_read_b64_tr_b16 v[44:45], v13 offset:0
    ds_read_b64_tr_b16 v[46:47], v13 offset:1024
    ds_read_b128 v[64:67], v8 offset:8192
    s_waitcnt lgkmcnt(0)
    v_mfma_f32_16x16x32_bf16 v[104:107], v[32:35], v[48:51], 0
    ds_read_b64_tr_b16 v[68:69], v10 offset:8192
    v_mfma_f32_16x16x32_bf16 v[108:111], v[32:35], v[52:55], 0
    ds_read_b64_tr_b16 v[70:71], v10 offset:9216
    v_mfma_f32_16x16x32_bf16 v[112:115], v[32:35], v[56:59], 0
    ds_read_b128 v[84:87], v9 offset:0
    v_mfma_f32_16x16x32_bf16 v[116:119], v[32:35], v[60:63], 0
    ds_read_b128 v[88:91], v9 offset:2048
    v_mfma_f32_16x16x32_bf16 v[120:123], v[32:35], v[64:67], 0
    ds_read_b64_tr_b16 v[72:73], v11 offset:8192
    v_mfma_f32_16x16x32_bf16 v[124:127], v[36:39], v[48:51], 0
    ds_read_b64_tr_b16 v[74:75], v11 offset:9216
    v_mfma_f32_16x16x32_bf16 v[128:131], v[36:39], v[52:55], 0
    ds_read_b128 v[92:95], v9 offset:4096
    v_mfma_f32_16x16x32_bf16 v[132:135], v[36:39], v[56:59], 0
    ds_read_b64_tr_b16 v[76:77], v12 offset:8192
    v_mfma_f32_16x16x32_bf16 v[136:139], v[36:39], v[60:63], 0
    ds_read_b64_tr_b16 v[78:79], v12 offset:9216
    v_mfma_f32_16x16x32_bf16 v[140:143], v[36:39], v[64:67], 0
    ds_read_b128 v[96:99], v9 offset:6144
    v_mfma_f32_16x16x32_bf16 v[144:147], v[40:43], v[48:51], 0
    ds_read_b64_tr_b16 v[80:81], v13 offset:8192
    v_mfma_f32_16x16x32_bf16 v[148:151], v[40:43], v[52:55], 0
    ds_read_b64_tr_b16 v[82:83], v13 offset:9216
    v_mfma_f32_16x16x32_bf16 v[152:155], v[40:43], v[56:59], 0
    ds_read_b128 v[100:103], v9 offset:8192
    v_mfma_f32_16x16x32_bf16 v[156:159], v[40:43], v[60:63], 0
    v_mfma_f32_16x16x32_bf16 v[160:163], v[40:43], v[64:67], 0
    s_add_u32 s44, s44, 1
    s_cmp_eq_u32 s44, 3
    v_mfma_f32_16x16x32_bf16 v[164:167], v[44:47], v[48:51], 0
    s_cselect_b32 s37, -2, 1
    s_cselect_b32 s44, 0, s44
    v_mfma_f32_16x16x32_bf16 v[168:171], v[44:47], v[52:55], 0
    s_mul_i32 s37, s37, 36864
    v_add_u32 v8, s37, v8
    v_mfma_f32_16x16x32_bf16 v[172:175], v[44:47], v[56:59], 0
    v_add_u32 v9, s37, v9
    v_add_u32 v10, s37, v10
    v_mfma_f32_16x16x32_bf16 v[176:179], v[44:47], v[60:63], 0
    v_add_u32 v11, s37, v11
    v_add_u32 v12, s37, v12
    v_mfma_f32_16x16x32_bf16 v[180:183], v[44:47], v[64:67], 0
    v_add_u32 v13, s37, v13
F_qloop:
    s_waitcnt lgkmcnt(0)
    s_barrier
    v_mfma_f32_16x16x32_bf16 v[104:107], v[68:71], v[84:87], v[104:107]
    ds_read_b64_tr_b16 v[32:33], v10 offset:0
    v_mfma_f32_16x16x32_bf16 v[108:111], v[68:71], v[88:91], v[108:111]
    ds_read_b64_tr_b16 v[34:35], v10 offset:1024
    v_mfma_f32_16x16x32_bf16 v[112:115], v[68:71], v[92:95], v[112:115]
    ds_read_b128 v[48:51], v8 offset:0
    v_mfma_f32_16x16x32_bf16 v[116:119], v[68:71], v[96:99], v[116:119]
    ds_read_b128 v[52:55], v8 offset:2048
    v_mfma_f32_16x16x32_bf16 v[120:123], v[68:71], v[100:103], v[120:123]
    ds_read_b64_tr_b16 v[36:37], v11 offset:0
    v_mfma_f32_16x16x32_bf16 v[124:127], v[72:75], v[84:87], v[124:127]
    ds_read_b64_tr_b16 v[38:39], v11 offset:1024
    v_mfma_f32_16x16x32_bf16 v[128:131], v[72:75], v[88:91], v[128:131]
    ds_read_b128 v[56:59], v8 offset:4096
    v_mfma_f32_16x16x32_bf16 v[132:135], v[72:75], v[92:95], v[132:135]
    ds_read_b64_tr_b16 v[40:41], v12 offset:0
    v_mfma_f32_16x16x32_bf16 v[136:139], v[72:75], v[96:99], v[136:139]
    ds_read_b64_tr_b16 v[42:43], v12 offset:1024
    v_mfma_f32_16x16x32_bf16 v[140:143], v[72:75], v[100:103], v[140:143]
    ds_read_b128 v[60:63], v8 offset:6144
    v_mfma_f32_16x16x32_bf16 v[144:147], v[76:79], v[84:87], v[144:147]
    ds_read_b64_tr_b16 v[44:45], v13 offset:0
    v_mfma_f32_16x16x32_bf16 v[148:151], v[76:79], v[88:91], v[148:151]
    ds_read_b64_tr_b16 v[46:47], v13 offset:1024
    v_mfma_f32_16x16x32_bf16 v[152:155], v[76:79], v[92:95], v[152:155]
    ds_read_b128 v[64:67], v8 offset:8192
    v_mfma_f32_16x16x32_bf16 v[156:159], v[76:79], v[96:99], v[156:159]
    v_mfma_f32_16x16x32_bf16 v[160:163], v[76:79], v[100:103], v[160:163]
    v_mfma_f32_16x16x32_bf16 v[164:167], v[80:83], v[84:87], v[164:167]
    v_mfma_f32_16x16x32_bf16 v[168:171], v[80:83], v[88:91], v[168:171]
    v_mfma_f32_16x16x32_bf16 v[172:175], v[80:83], v[92:95], v[172:175]
    v_mfma_f32_16x16x32_bf16 v[176:179], v[80:83], v[96:99], v[176:179]
    v_mfma_f32_16x16x32_bf16 v[180:183], v[80:83], v[100:103], v[180:183]
    s_waitcnt lgkmcnt(0)
    v_mfma_f32_16x16x32_bf16 v[104:107], v[32:35], v[48:51], v[104:107]
    ds_read_b64_tr_b16 v[68:69], v10 offset:8192
    v_mfma_f32_16x16x32_bf16 v[108:111], v[32:35], v[52:55], v[108:111]
    ds_read_b64_tr_b16 v[70:71], v10 offset:9216
    v_mfma_f32_16x16x32_bf16 v[112:115], v[32:35], v[56:59], v[112:115]
    ds_read_b128 v[84:87], v9 offset:0
    v_mfma_f32_16x16x32_bf16 v[116:119], v[32:35], v[60:63], v[116:119]
    ds_read_b128 v[88:91], v9 offset:2048
    v_mfma_f32_16x16x32_bf16 v[120:123], v[32:35], v[64:67], v[120:123]
    ds_read_b64_tr_b16 v[72:73], v11 offset:8192
    v_mfma_f32_16x16x32_bf16 v[124:127], v[36:39], v[48:51], v[124:127]
    ds_read_b64_tr_b16 v[74:75], v11 offset:9216
    v_mfma_f32_16x16x32_bf16 v[128:131], v[36:39], v[52:55], v[128:131]
    ds_read_b128 v[92:95], v9 offset:4096
    v_mfma_f32_16x16x32_bf16 v[132:135], v[36:39], v[56:59], v[132:135]
    ds_read_b64_tr_b16 v[76:77], v12 offset:8192
    v_mfma_f32_16x16x32_bf16 v[136:139], v[36:39], v[60:63], v[136:139]
    ds_read_b64_tr_b16 v[78:79], v12 offset:9216
    v_mfma_f32_16x16x32_bf16 v[140:143], v[36:39], v[64:67], v[140:143]
    ds_read_b128 v[96:99], v9 offset:6144
    v_mfma_f32_16x16x32_bf16 v[144:147], v[40:43], v[48:51], v[144:147]
    ds_read_b64_tr_b16 v[80:81], v13 offset:8192
    v_mfma_f32_16x16x32_bf16 v[148:151], v[40:43], v[52:55], v[148:151]
    ds_read_b64_tr_b16 v[82:83], v13 offset:9216
    v_mfma_f32_16x16x32_bf16 v[152:155], v[40:43], v[56:59], v[152:155]
    ds_read_b128 v[100:103], v9 offset:8192
    v_mfma_f32_16x16x32_bf16 v[156:159], v[40:43], v[60:63], v[156:159]
    v_mfma_f32_16x16x32_bf16 v[160:163], v[40:43], v[64:67], v[160:163]
    s_add_u32 s44, s44, 1
    s_cmp_eq_u32 s44, 3
    s_cselect_b32 s37, -2, 1
    v_mfma_f32_16x16x32_bf16 v[164:167], v[44:47], v[48:51], v[164:167]
    s_cselect_b32 s44, 0, s44
    s_mul_i32 s37, s37, 36864
    v_mfma_f32_16x16x32_bf16 v[168:171], v[44:47], v[52:55], v[168:171]
    v_add_u32 v8, s37, v8
    v_add_u32 v9, s37, v9
    v_mfma_f32_16x16x32_bf16 v[172:175], v[44:47], v[56:59], v[172:175]
    v_add_u32 v10, s37, v10
    v_add_u32 v11, s37, v11
    v_mfma_f32_16x16x32_bf16 v[176:179], v[44:47], v[60:63], v[176:179]
    v_add_u32 v12, s37, v12
    v_add_u32 v13, s37, v13
    v_mfma_f32_16x16x32_bf16 v[180:183], v[44:47], v[64:67], v[180:183]
    s_sub_u32 s38, s38, 1
    s_cmp_lg_u32 s38, 0
    s_cbranch_scc1 F_qloop
    s_waitcnt vmcnt(0) lgkmcnt(0)
    s_barrier
    v_mfma_f32_16x16x32_bf16 v[104:107], v[68:71], v[84:87], v[104:107]
    ds_read_b64_tr_b16 v[32:33], v10 offset:0
    ds_read_b64_tr_b16 v[34:35], v10 offset:1024
    v_mfma_f32_16x16x32_bf16 v[108:111], v[68:71], v[88:91], v[108:111]
    ds_read_b128 v[48:51], v8 offset:0
    ds_read_b128 v[52:55], v8 offset:2048
    v_mfma_f32_16x16x32_bf16 v[112:115], v[68:71], v[92:95], v[112:115]
    ds_read_b64_tr_b16 v[36:37], v11 offset:0
    v_mfma_f32_16x16x32_bf16 v[116:119], v[68:71], v[96:99], v[116:119]
    ds_read_b64_tr_b16 v[38:39], v11 offset:1024
    ds_read_b128 v[56:59], v8 offset:4096
    v_mfma_f32_16x16x32_bf16 v[120:123], v[68:71], v[100:103], v[120:123]
    ds_read_b64_tr_b16 v[40:41], v12 offset:0
    ds_read_b64_tr_b16 v[42:43], v12 offset:1024
    v_mfma_f32_16x16x32_bf16 v[124:127], v[72:75], v[84:87], v[124:127]
    ds_read_b128 v[60:63], v8 offset:6144
    v_mfma_f32_16x16x32_bf16 v[128:131], v[72:75], v[88:91], v[128:131]
    ds_read_b64_tr_b16 v[44:45], v13 offset:0
    ds_read_b64_tr_b16 v[46:47], v13 offset:1024
    v_mfma_f32_16x16x32_bf16 v[132:135], v[72:75], v[92:95], v[132:135]
    ds_read_b128 v[64:67], v8 offset:8192
    v_mfma_f32_16x16x32_bf16 v[136:139], v[72:75], v[96:99], v[136:139]
    ds_read_b64_tr_b16 v[192:193], v10 offset:8192
    ds_read_b64_tr_b16 v[194:195], v10 offset:9216
    v_mfma_f32_16x16x32_bf16 v[140:143], v[72:75], v[100:103], v[140:143]
    ds_read_b128 v[208:211], v9 offset:0
    ds_read_b128 v[212:215], v9 offset:2048
    v_mfma_f32_16x16x32_bf16 v[144:147], v[76:79], v[84:87], v[144:147]
    ds_read_b64_tr_b16 v[196:197], v11 offset:8192
    v_mfma_f32_16x16x32_bf16 v[148:151], v[76:79], v[88:91], v[148:151]
    ds_read_b64_tr_b16 v[198:199], v11 offset:9216
    ds_read_b128 v[216:219], v9 offset:4096
    v_mfma_f32_16x16x32_bf16 v[152:155], v[76:79], v[92:95], v[152:155]
    ds_read_b64_tr_b16 v[200:201], v12 offset:8192
    ds_read_b64_tr_b16 v[202:203], v12 offset:9216
    v_mfma_f32_16x16x32_bf16 v[156:159], v[76:79], v[96:99], v[156:159]
    ds_read_b128 v[220:223], v9 offset:6144
    v_mfma_f32_16x16x32_bf16 v[160:163], v[76:79], v[100:103], v[160:163]
    ds_read_b64_tr_b16 v[204:205], v13 offset:8192
    ds_read_b64_tr_b16 v[206:207], v13 offset:9216
    v_mfma_f32_16x16x32_bf16 v[164:167], v[80:83], v[84:87], v[164:167]
    ds_read_b128 v[224:227], v9 offset:8192
    v_mfma_f32_16x16x32_bf16 v[168:171], v[80:83], v[88:91], v[168:171]
    v_mfma_f32_16x16x32_bf16 v[172:175], v[80:83], v[92:95], v[172:175]
    v_mfma_f32_16x16x32_bf16 v[176:179], v[80:83], v[96:99], v[176:179]
    v_mfma_f32_16x16x32_bf16 v[180:183], v[80:83], v[100:103], v[180:183]
    s_waitcnt lgkmcnt(0)
    s_barrier
    v_mfma_f32_16x16x32_bf16 v[104:107], v[32:35], v[48:51], v[104:107]
    v_mfma_f32_16x16x32_bf16 v[104:107], v[192:195], v[208:211], v[104:107]
    v_mfma_f32_16x16x32_bf16 v[124:127], v[36:39], v[48:51], v[124:127]
    v_mfma_f32_16x16x32_bf16 v[124:127], v[196:199], v[208:211], v[124:127]
    v_mfma_f32_16x16x32_bf16 v[144:147], v[40:43], v[48:51], v[144:147]
    s_nop 4
    v_mul_f32 v104, s49, v104
    v_mul_f32 v105, s49, v105
    v_mul_f32 v106, s49, v106
    v_mfma_f32_16x16x32_bf16 v[144:147], v[200:203], v[208:211], v[144:147]
    v_mul_f32 v107, s49, v107
    v_mfma_f32_16x16x32_bf16 v[164:167], v[44:47], v[48:51], v[164:167]
    v_mul_f32 v124, s49, v124
    v_mul_f32 v125, s49, v125
    v_cvt_pk_bf16_f32 v68, v104, v105
    v_mfma_f32_16x16x32_bf16 v[164:167], v[204:207], v[208:211], v[164:167]
    v_mul_f32 v126, s49, v126
    v_mul_f32 v127, s49, v127
    v_cvt_pk_bf16_f32 v69, v106, v107
    v_mfma_f32_16x16x32_bf16 v[108:111], v[32:35], v[52:55], v[108:111]
    v_cvt_pk_bf16_f32 v70, v124, v125
    v_mul_f32 v144, s49, v144
    v_mul_f32 v145, s49, v145
    v_mul_f32 v146, s49, v146
    v_mfma_f32_16x16x32_bf16 v[108:111], v[192:195], v[212:215], v[108:111]
    v_cvt_pk_bf16_f32 v71, v126, v127
    v_mul_f32 v147, s49, v147
    v_mfma_f32_16x16x32_bf16 v[128:131], v[36:39], v[52:55], v[128:131]
    ds_write2st64_b64 v186, v[68:69], v[70:71] offset0:0 offset1:2
    v_mul_f32 v164, s49, v164
    v_mul_f32 v165, s49, v165
    v_cvt_pk_bf16_f32 v72, v144, v145
    v_mfma_f32_16x16x32_bf16 v[128:131], v[196:199], v[212:215], v[128:131]
    v_mul_f32 v166, s49, v166
    v_mul_f32 v167, s49, v167
    v_cvt_pk_bf16_f32 v73, v146, v147
    v_mfma_f32_16x16x32_bf16 v[148:151], v[40:43], v[52:55], v[148:151]
    v_cvt_pk_bf16_f32 v74, v164, v165
    v_mul_f32 v108, s49, v108
    v_mul_f32 v109, s49, v109
    v_mul_f32 v110, s49, v110
    v_mfma_f32_16x16x32_bf16 v[148:151], v[200:203], v[212:215], v[148:151]
    v_cvt_pk_bf16_f32 v75, v166, v167
    v_mul_f32 v111, s49, v111
    v_mfma_f32_16x16x32_bf16 v[168:171], v[44:47], v[52:55], v[168:171]
    ds_write2st64_b64 v186, v[72:73], v[74:75] offset0:4 offset1:6
    v_mul_f32 v128, s49, v128
    v_mul_f32 v129, s49, v129
    v_cvt_pk_bf16_f32 v76, v108, v109
    v_mfma_f32_16x16x32_bf16 v[168:171], v[204:207], v[212:215], v[168:171]
    v_mul_f32 v130, s49, v130
    v_mul_f32 v131, s49, v131
    v_cvt_pk_bf16_f32 v77, v110, v111
    v_mfma_f32_16x16x32_bf16 v[112:115], v[32:35], v[56:59], v[112:115]
    v_cvt_pk_bf16_f32 v78, v128, v129
    v_mul_f32 v148, s49, v148
    v_mul_f32 v149, s49, v149
    v_mul_f32 v150, s49, v150
    v_mfma_f32_16x16x32_bf16 v[112:115], v[192:195], v[216:219], v[112:115]
    v_cvt_pk_bf16_f32 v79, v130, v131
    v_mul_f32 v151, s49, v151
    v_mfma_f32_16x16x32_bf16 v[132:135], v[36:39], v[56:59], v[132:135]
    ds_write2st64_b64 v187, v[76:77], v[78:79] offset0:0 offset1:2
    v_mul_f32 v168, s49, v168
    v_mul_f32 v169, s49, v169
    v_cvt_pk_bf16_f32 v80, v148, v149
    v_mfma_f32_16x16x32_bf16 v[132:135], v[196:199], v[216:219], v[132:135]
    v_mul_f32 v170, s49, v170
    v_mul_f32 v171, s49, v171
    v_cvt_pk_bf16_f32 v81, v150, v151
    v_mfma_f32_16x16x32_bf16 v[152:155], v[40:43], v[56:59], v[152:155]
    v_cvt_pk_bf16_f32 v82, v168, v169
    v_mul_f32 v112, s49, v112
    v_mul_f32 v113, s49, v113
    v_mul_f32 v114, s49, v114
    v_mfma_f32_16x16x32_bf16 v[152:155], v[200:203], v[216:219], v[152:155]
    v_cvt_pk_bf16_f32 v83, v170, v171
    v_mul_f32 v115, s49, v115
    v_mfma_f32_16x16x32_bf16 v[172:175], v[44:47], v[56:59], v[172:175]
    ds_write2st64_b64 v187, v[80:81], v[82:83] offset0:4 offset1:6
    v_mul_f32 v132, s49, v132
    v_mul_f32 v133, s49, v133
    v_cvt_pk_bf16_f32 v84, v112, v113
    v_mfma_f32_16x16x32_bf16 v[172:175], v[204:207], v[216:219], v[172:175]
    v_mul_f32 v134, s49, v134
    v_mul_f32 v135, s49, v135
    v_cvt_pk_bf16_f32 v85, v114, v115
    v_mfma_f32_16x16x32_bf16 v[116:119], v[32:35], v[60:63], v[116:119]
    v_cvt_pk_bf16_f32 v86, v132, v133
    v_mul_f32 v152, s49, v152
    v_mul_f32 v153, s49, v153
    v_mul_f32 v154, s49, v154
    v_mfma_f32_16x16x32_bf16 v[116:119], v[192:195], v[220:223], v[116:119]
    v_cvt_pk_bf16_f32 v87, v134, v135
    v_mul_f32 v155, s49, v155
    v_mfma_f32_16x16x32_bf16 v[136:139], v[36:39], v[60:63], v[136:139]
    ds_write2st64_b64 v186, v[84:85], v[86:87] offset0:16 offset1:18
    v_mul_f32 v172, s49, v172
    v_mul_f32 v173, s49, v173
    v_cvt_pk_bf16_f32 v88, v152, v153
    v_mfma_f32_16x16x32_bf16 v[136:139], v[196:199], v[220:223], v[136:139]
    v_mul_f32 v174, s49, v174
    v_mul_f32 v175, s49, v175
    v_cvt_pk_bf16_f32 v89, v154, v155
    v_mfma_f32_16x16x32_bf16 v[156:159], v[40:43], v[60:63], v[156:159]
    v_cvt_pk_bf16_f32 v90, v172, v173
    v_mul_f32 v116, s49, v116
    v_mul_f32 v117, s49, v117
    v_mul_f32 v118, s49, v118
    v_mfma_f32_16x16x32_bf16 v[156:159], v[200:203], v[220:223], v[156:159]
    v_cvt_pk_bf16_f32 v91, v174, v175
    v_mul_f32 v119, s49, v119
    v_mfma_f32_16x16x32_bf16 v[176:179], v[44:47], v[60:63], v[176:179]
    ds_write2st64_b64 v186, v[88:89], v[90:91] offset0:20 offset1:22
    v_mul_f32 v136, s49, v136
    v_mul_f32 v137, s49, v137
    v_cvt_pk_bf16_f32 v92, v116, v117
    v_mfma_f32_16x16x32_bf16 v[176:179], v[204:207], v[220:223], v[176:179]
    v_mul_f32 v138, s49, v138
    v_mul_f32 v139, s49, v139
    v_cvt_pk_bf16_f32 v93, v118, v119
    v_mfma_f32_16x16x32_bf16 v[120:123], v[32:35], v[64:67], v[120:123]
    v_cvt_pk_bf16_f32 v94, v136, v137
    v_mul_f32 v156, s49, v156
    v_mul_f32 v157, s49, v157
    v_mul_f32 v158, s49, v158
    v_mfma_f32_16x16x32_bf16 v[120:123], v[192:195], v[224:227], v[120:123]
    v_cvt_pk_bf16_f32 v95, v138, v139
    v_mul_f32 v159, s49, v159
    v_mfma_f32_16x16x32_bf16 v[140:143], v[36:39], v[64:67], v[140:143]
    ds_write2st64_b64 v187, v[92:93], v[94:95] offset0:16 offset1:18
    v_mul_f32 v176, s49, v176
    v_mul_f32 v177, s49, v177
    v_cvt_pk_bf16_f32 v96, v156, v157
    v_mfma_f32_16x16x32_bf16 v[140:143], v[196:199], v[224:227], v[140:143]
    v_mul_f32 v178, s49, v178
    v_mul_f32 v179, s49, v179
    v_cvt_pk_bf16_f32 v97, v158, v159
    v_mfma_f32_16x16x32_bf16 v[160:163], v[40:43], v[64:67], v[160:163]
    v_cvt_pk_bf16_f32 v98, v176, v177
    v_mul_f32 v120, s49, v120
    v_mul_f32 v121, s49, v121
    v_mul_f32 v122, s49, v122
    v_mfma_f32_16x16x32_bf16 v[160:163], v[200:203], v[224:227], v[160:163]
    v_cvt_pk_bf16_f32 v99, v178, v179
    v_mul_f32 v123, s49, v123
    v_mfma_f32_16x16x32_bf16 v[180:183], v[44:47], v[64:67], v[180:183]
    ds_write2st64_b64 v187, v[96:97], v[98:99] offset0:20 offset1:22
    v_mul_f32 v140, s49, v140
    v_mul_f32 v141, s49, v141
    v_cvt_pk_bf16_f32 v68, v120, v121
    v_mfma_f32_16x16x32_bf16 v[180:183], v[204:207], v[224:227], v[180:183]
    v_mul_f32 v142, s49, v142
    v_mul_f32 v143, s49, v143
    v_cvt_pk_bf16_f32 v69, v122, v123
    v_cvt_pk_bf16_f32 v70, v140, v141
    v_mul_f32 v160, s49, v160
    v_mul_f32 v161, s49, v161
    v_mul_f32 v162, s49, v162
    v_cvt_pk_bf16_f32 v71, v142, v143
    v_mul_f32 v163, s49, v163
    ds_write2st64_b64 v186, v[68:69], v[70:71] offset0:32 offset1:34
    v_mul_f32 v180, s49, v180
    v_mul_f32 v181, s49, v181
    v_cvt_pk_bf16_f32 v72, v160, v161
    v_mul_f32 v182, s49, v182
    v_mul_f32 v183, s49, v183
    v_cvt_pk_bf16_f32 v73, v162, v163
    v_cvt_pk_bf16_f32 v74, v180, v181
    v_cvt_pk_bf16_f32 v75, v182, v183
    ds_write2st64_b64 v186, v[72:73], v[74:75] offset0:36 offset1:38
    ds_read_b128 v[128:131], v16 offset:0
    ds_read_b128 v[132:135], v17 offset:0
    ds_read_b128 v[136:139], v18 offset:0
    ds_read_b128 v[140:143], v19 offset:0
    ds_read_b128 v[144:147], v20 offset:0
    ds_read_b128 v[148:151], v21 offset:0
    ds_read_b128 v[152:155], v22 offset:0
    ds_read_b128 v[156:159], v23 offset:0
    s_waitcnt lgkmcnt(8)
    s_barrier
    ds_read_b128 v[32:35], v188 offset:0
    ds_read_b128 v[36:39], v188 offset:1024
    ds_read_b128 v[40:43], v188 offset:2048
    ds_read_b128 v[44:47], v188 offset:3072
    ds_read_b128 v[48:51], v188 offset:4096
    ds_read_b128 v[52:55], v188 offset:5120
    ds_read_b128 v[56:59], v188 offset:6144
    ds_read_b128 v[60:63], v188 offset:7168
    v_lshlrev_b32 v8, 4, v1
    v_add_u32 v9, 1024, v8
    v_and_b32 v6, 1, v2
    v_lshl_or_b32 v6, v6, 2, v4
    v_lshrrev_b32 v7, 1, v2
    v_lshl_add_u32 v7, v7, 4, v6
    s_lshl_b32 s37, s18, 1
    v_xor_b32 v6, s37, v6
    v_lshlrev_b32 v6, 5, v6
    v_lshl_add_u32 v6, v7, 8, v6
    v_lshl_add_u32 v6, v5, 3, v6
    v_add_u32 v10, 98304, v6
    v_xor_b32 v11, 32, v10
    v_xor_b32 v12, 64, v10
    v_xor_b32 v13, 96, v10
    s_waitcnt lgkmcnt(7)
    v_mfma_f32_32x32x16_bf16 v[64:79], v[128:131], v[32:35], 0
    ds_read_b128 v[128:131], v16 offset:8192
    v_mov_b32 v96, 0
    v_mov_b32 v97, 0
    s_waitcnt lgkmcnt(7)
    v_mfma_f32_32x32x16_bf16 v[64:79], v[132:135], v[36:39], v[64:79]
    ds_read_b128 v[132:135], v17 offset:8192
    v_mov_b32 v98, 0
    v_mov_b32 v99, 0
    s_waitcnt lgkmcnt(7)
    v_mfma_f32_32x32x16_bf16 v[64:79], v[136:139], v[40:43], v[64:79]
    ds_read_b128 v[136:139], v18 offset:8192
    v_mov_b32 v100, 0
    v_mov_b32 v101, 0
    s_waitcnt lgkmcnt(7)
    v_mfma_f32_32x32x16_bf16 v[64:79], v[140:143], v[44:47], v[64:79]
    ds_read_b128 v[140:143], v19 offset:8192
    v_mov_b32 v102, 0
    v_mov_b32 v103, 0
    s_waitcnt lgkmcnt(7)
    v_mfma_f32_32x32x16_bf16 v[64:79], v[144:147], v[48:51], v[64:79]
    ds_read_b128 v[144:147], v20 offset:8192
    v_mov_b32 v104, 0
    v_mov_b32 v105, 0
    s_waitcnt lgkmcnt(7)
    v_mfma_f32_32x32x16_bf16 v[64:79], v[148:151], v[52:55], v[64:79]
    ds_read_b128 v[148:151], v21 offset:8192
    v_mov_b32 v106, 0
    v_mov_b32 v107, 0
    s_waitcnt lgkmcnt(7)
    v_mfma_f32_32x32x16_bf16 v[64:79], v[152:155], v[56:59], v[64:79]
    ds_read_b128 v[152:155], v22 offset:8192
    v_mov_b32 v108, 0
    v_mov_b32 v109, 0
    s_waitcnt lgkmcnt(7)
    v_mfma_f32_32x32x16_bf16 v[64:79], v[156:159], v[60:63], v[64:79]
    ds_read_b128 v[156:159], v23 offset:8192
    v_mov_b32 v110, 0
    v_mov_b32 v111, 0
    s_waitcnt lgkmcnt(4)
    v_mfma_f32_32x32x16_bf16 v[80:95], v[128:131], v[32:35], 0
    v_mfma_f32_32x32x16_bf16 v[80:95], v[132:135], v[36:39], v[80:95]
    s_waitcnt lgkmcnt(0)
    s_barrier
    ds_read_b128 v[128:131], v16 offset:16384
    ds_read_b128 v[132:135], v17 offset:16384
    v_mfma_f32_32x32x16_bf16 v[80:95], v[136:139], v[40:43], v[80:95]
    ds_read_b128 v[136:139], v18 offset:16384
    s_nop 2
    v_mfma_f32_32x32x16_bf16 v[80:95], v[140:143], v[44:47], v[80:95]
    ds_read_b128 v[140:143], v19 offset:16384
    v_exp_f32 v2, v64
    v_exp_f32 v3, v65
    v_exp_f32 v4, v66
    v_mfma_f32_32x32x16_bf16 v[80:95], v[144:147], v[48:51], v[80:95]
    ds_read_b128 v[144:147], v20 offset:16384
    v_exp_f32 v5, v67
    v_add_f32 v15, v2, v3
    v_cvt_pk_bf16_f32 v112, v2, v3
    v_exp_f32 v6, v68
    v_mfma_f32_32x32x16_bf16 v[80:95], v[148:151], v[52:55], v[80:95]
    ds_read_b128 v[148:151], v21 offset:16384
    v_exp_f32 v7, v69
    v_add_f32 v28, v4, v5
    v_cvt_pk_bf16_f32 v113, v4, v5
    v_exp_f32 v2, v70
    v_mfma_f32_32x32x16_bf16 v[80:95], v[152:155], v[56:59], v[80:95]
    ds_read_b128 v[152:155], v22 offset:16384
    v_exp_f32 v3, v71
    v_add_f32 v15, v15, v6
    v_add_f32 v28, v28, v7
    v_cvt_pk_bf16_f32 v114, v6, v7
    v_mfma_f32_32x32x16_bf16 v[80:95], v[156:159], v[60:63], v[80:95]
    ds_read_b128 v[156:159], v23 offset:16384
    v_exp_f32 v4, v72
    v_exp_f32 v5, v73
    v_add_f32 v15, v15, v2
    ds_read_b64_tr_b16 v[160:161], v24 offset:16384
    v_add_f32 v28, v28, v3
    ds_read_b64_tr_b16 v[162:163], v24 offset:18432
    v_cvt_pk_bf16_f32 v115, v2, v3
    ds_read_b64_tr_b16 v[164:165], v25 offset:16384
    v_exp_f32 v6, v74
    ds_read_b64_tr_b16 v[166:167], v25 offset:18432
    v_exp_f32 v7, v75
    ds_read_b64_tr_b16 v[168:169], v26 offset:16384
    v_add_f32 v15, v15, v4
    ds_read_b64_tr_b16 v[170:171], v26 offset:18432
    v_add_f32 v28, v28, v5
    ds_read_b64_tr_b16 v[172:173], v27 offset:16384
    v_cvt_pk_bf16_f32 v116, v4, v5
    ds_read_b64_tr_b16 v[174:175], v27 offset:18432
    v_exp_f32 v2, v76
    ds_read_b64_tr_b16 v[176:177], v24 offset:20480
    v_exp_f32 v3, v77
    ds_read_b64_tr_b16 v[178:179], v24 offset:22528
    v_add_f32 v15, v15, v6
    ds_read_b64_tr_b16 v[180:181], v25 offset:20480
    v_add_f32 v28, v28, v7
    ds_read_b64_tr_b16 v[182:183], v25 offset:22528
    v_cvt_pk_bf16_f32 v117, v6, v7
    v_exp_f32 v4, v78
    v_exp_f32 v5, v79
    v_add_f32 v15, v15, v2
    v_add_f32 v28, v28, v3
    v_cvt_pk_bf16_f32 v118, v2, v3
    v_add_f32 v15, v15, v4
    v_add_f32 v28, v28, v5
    v_cvt_pk_bf16_f32 v119, v4, v5
    v_add_f32 v15, v15, v28
    v_mov_b32 v29, 0x38800000
    v_med3_f32 v29, v15, s32, v29
    v_cmp_neq_f32 vcc, v29, v15
    ds_read_b64_tr_b16 v[184:185], v26 offset:20480
    ds_read_b64_tr_b16 v[186:187], v26 offset:22528
    ds_read_b64_tr_b16 v[188:189], v27 offset:20480
    ds_read_b64_tr_b16 v[190:191], v27 offset:22528
    s_cbranch_vccnz F_tr_u0
F_bk_u0:
    v_add_f32 v14, v14, v15
    s_waitcnt lgkmcnt(15)
    v_mfma_f32_32x32x16_bf16 v[64:79], v[128:131], v[32:35], v[96:111]
    ds_read_b128 v[128:131], v16 offset:24576
    v_exp_f32 v2, v80
    v_exp_f32 v3, v81
    v_mfma_f32_32x32x16_bf16 v[64:79], v[132:135], v[36:39], v[64:79]
    ds_read_b128 v[132:135], v17 offset:24576
    v_exp_f32 v4, v82
    v_exp_f32 v5, v83
    v_add_f32 v15, v2, v3
    v_mfma_f32_32x32x16_bf16 v[64:79], v[136:139], v[40:43], v[64:79]
    ds_read_b128 v[136:139], v18 offset:24576
    v_cvt_pk_bf16_f32 v120, v2, v3
    v_exp_f32 v6, v84
    v_exp_f32 v7, v85
    v_mfma_f32_32x32x16_bf16 v[64:79], v[140:143], v[44:47], v[64:79]
    ds_read_b128 v[140:143], v19 offset:24576
    v_add_f32 v28, v4, v5
    v_cvt_pk_bf16_f32 v121, v4, v5
    v_exp_f32 v2, v86
    v_mfma_f32_32x32x16_bf16 v[64:79], v[144:147], v[48:51], v[64:79]
    ds_read_b128 v[144:147], v20 offset:24576
    v_exp_f32 v3, v87
    v_add_f32 v15, v15, v6
    v_add_f32 v28, v28, v7
    v_cvt_pk_bf16_f32 v122, v6, v7
    v_mfma_f32_32x32x16_bf16 v[64:79], v[148:151], v[52:55], v[64:79]
    ds_read_b128 v[148:151], v21 offset:24576
    v_exp_f32 v4, v88
    v_exp_f32 v5, v89
    v_add_f32 v15, v15, v2
    v_mfma_f32_32x32x16_bf16 v[64:79], v[152:155], v[56:59], v[64:79]
    ds_read_b128 v[152:155], v22 offset:24576
    v_add_f32 v28, v28, v3
    v_cvt_pk_bf16_f32 v123, v2, v3
    v_exp_f32 v6, v90
    v_mfma_f32_32x32x16_bf16 v[64:79], v[156:159], v[60:63], v[64:79]
    ds_read_b128 v[156:159], v23 offset:24576
    s_waitcnt lgkmcnt(8)
    v_exp_f32 v7, v91
    v_add_f32 v15, v15, v4
    v_add_f32 v28, v28, v5
    v_mfma_f32_32x32x16_bf16 v[192:207], v[160:163], v[112:115], 0
    ds_read_b64_tr_b16 v[160:161], v24 offset:24576
    ds_read_b64_tr_b16 v[162:163], v24 offset:26624
    v_cvt_pk_bf16_f32 v124, v4, v5
    v_exp_f32 v2, v92
    v_mfma_f32_32x32x16_bf16 v[208:223], v[164:167], v[112:115], 0
    ds_read_b64_tr_b16 v[164:165], v25 offset:24576
    ds_read_b64_tr_b16 v[166:167], v25 offset:26624
    v_exp_f32 v3, v93
    v_add_f32 v15, v15, v6
    v_add_f32 v28, v28, v7
    v_mfma_f32_32x32x16_bf16 v[224:239], v[168:171], v[112:115], 0
    ds_read_b64_tr_b16 v[168:169], v26 offset:24576
    ds_read_b64_tr_b16 v[170:171], v26 offset:26624
    v_cvt_pk_bf16_f32 v125, v6, v7
    v_exp_f32 v4, v94
    v_mfma_f32_32x32x16_bf16 v[240:255], v[172:175], v[112:115], 0
    ds_read_b64_tr_b16 v[172:173], v27 offset:24576
    ds_read_b64_tr_b16 v[174:175], v27 offset:26624
    v_exp_f32 v5, v95
    v_add_f32 v15, v15, v2
    v_add_f32 v28, v28, v3
    v_mfma_f32_32x32x16_bf16 v[192:207], v[176:179], v[116:119], v[192:207]
    ds_read_b64_tr_b16 v[176:177], v24 offset:28672
    ds_read_b64_tr_b16 v[178:179], v24 offset:30720
    v_cvt_pk_bf16_f32 v126, v2, v3
    v_add_f32 v15, v15, v4
    v_add_f32 v28, v28, v5
    v_cvt_pk_bf16_f32 v127, v4, v5
    v_mfma_f32_32x32x16_bf16 v[208:223], v[180:183], v[116:119], v[208:223]
    ds_read_b64_tr_b16 v[180:181], v25 offset:28672
    ds_read_b64_tr_b16 v[182:183], v25 offset:30720
    v_add_f32 v15, v15, v28
    v_cmp_lt_f32 vcc, s32, v15
    v_mfma_f32_32x32x16_bf16 v[224:239], v[184:187], v[116:119], v[224:239]
    ds_read_b64_tr_b16 v[184:185], v26 offset:28672
    ds_read_b64_tr_b16 v[186:187], v26 offset:30720
    v_mfma_f32_32x32x16_bf16 v[240:255], v[188:191], v[116:119], v[240:255]
    ds_read_b64_tr_b16 v[188:189], v27 offset:28672
    ds_read_b64_tr_b16 v[190:191], v27 offset:30720
    s_cbranch_vccnz F_tr_u1
F_bk_u1:
    v_add_f32 v14, v14, v15
    s_waitcnt lgkmcnt(15)
    v_mfma_f32_32x32x16_bf16 v[80:95], v[128:131], v[32:35], v[96:111]
    v_exp_f32 v2, v64
    v_exp_f32 v3, v65
    v_exp_f32 v4, v66
    v_mfma_f32_32x32x16_bf16 v[80:95], v[132:135], v[36:39], v[80:95]
    s_waitcnt lgkmcnt(0)
    s_barrier
    ds_read_b128 v[128:131], v16 offset:49152
    v_exp_f32 v5, v67
    v_add_f32 v15, v2, v3
    v_mfma_f32_32x32x16_bf16 v[80:95], v[136:139], v[40:43], v[80:95]
    ds_read_b128 v[132:135], v17 offset:49152
    ds_read_b128 v[136:139], v18 offset:49152
    v_cvt_pk_bf16_f32 v112, v2, v3
    v_exp_f32 v6, v68
    v_mfma_f32_32x32x16_bf16 v[80:95], v[140:143], v[44:47], v[80:95]
    ds_read_b128 v[140:143], v19 offset:49152
    v_exp_f32 v7, v69
    v_add_f32 v28, v4, v5
    v_cvt_pk_bf16_f32 v113, v4, v5
    v_mfma_f32_32x32x16_bf16 v[80:95], v[144:147], v[48:51], v[80:95]
    ds_read_b128 v[144:147], v20 offset:49152
    v_exp_f32 v2, v70
    v_exp_f32 v3, v71
    v_add_f32 v15, v15, v6
    v_mfma_f32_32x32x16_bf16 v[80:95], v[148:151], v[52:55], v[80:95]
    ds_read_b128 v[148:151], v21 offset:49152
    v_add_f32 v28, v28, v7
    v_cvt_pk_bf16_f32 v114, v6, v7
    v_exp_f32 v4, v72
    v_mfma_f32_32x32x16_bf16 v[80:95], v[152:155], v[56:59], v[80:95]
    ds_read_b128 v[152:155], v22 offset:49152
    v_exp_f32 v5, v73
    v_add_f32 v15, v15, v2
    v_add_f32 v28, v28, v3
    v_cvt_pk_bf16_f32 v115, v2, v3
    v_mfma_f32_32x32x16_bf16 v[80:95], v[156:159], v[60:63], v[80:95]
    ds_read_b128 v[156:159], v23 offset:49152
    v_exp_f32 v6, v74
    v_exp_f32 v7, v75
    v_add_f32 v15, v15, v4
    v_mfma_f32_32x32x16_bf16 v[192:207], v[160:163], v[120:123], v[192:207]
    ds_read_b64_tr_b16 v[160:161], v24 offset:49152
    ds_read_b64_tr_b16 v[162:163], v24 offset:51200
    v_add_f32 v28, v28, v5
    v_cvt_pk_bf16_f32 v116, v4, v5
    v_exp_f32 v2, v76
    v_mfma_f32_32x32x16_bf16 v[208:223], v[164:167], v[120:123], v[208:223]
    ds_read_b64_tr_b16 v[164:165], v25 offset:49152
    ds_read_b64_tr_b16 v[166:167], v25 offset:51200
    v_exp_f32 v3, v77
    v_add_f32 v15, v15, v6
    v_add_f32 v28, v28, v7
    v_mfma_f32_32x32x16_bf16 v[224:239], v[168:171], v[120:123], v[224:239]
    ds_read_b64_tr_b16 v[168:169], v26 offset:49152
    ds_read_b64_tr_b16 v[170:171], v26 offset:51200
    v_cvt_pk_bf16_f32 v117, v6, v7
    v_exp_f32 v4, v78
    v_mfma_f32_32x32x16_bf16 v[240:255], v[172:175], v[120:123], v[240:255]
    ds_read_b64_tr_b16 v[172:173], v27 offset:49152
    ds_read_b64_tr_b16 v[174:175], v27 offset:51200
    v_exp_f32 v5, v79
    v_add_f32 v15, v15, v2
    v_add_f32 v28, v28, v3
    v_mfma_f32_32x32x16_bf16 v[192:207], v[176:179], v[124:127], v[192:207]
    ds_read_b64_tr_b16 v[176:177], v24 offset:53248
    ds_read_b64_tr_b16 v[178:179], v24 offset:55296
    v_cvt_pk_bf16_f32 v118, v2, v3
    v_add_f32 v15, v15, v4
    v_add_f32 v28, v28, v5
    v_cvt_pk_bf16_f32 v119, v4, v5
    v_mfma_f32_32x32x16_bf16 v[208:223], v[180:183], v[124:127], v[208:223]
    ds_read_b64_tr_b16 v[180:181], v25 offset:53248
    ds_read_b64_tr_b16 v[182:183], v25 offset:55296
    v_add_f32 v15, v15, v28
    v_cmp_lt_f32 vcc, s32, v15
    v_mfma_f32_32x32x16_bf16 v[224:239], v[184:187], v[124:127], v[224:239]
    ds_read_b64_tr_b16 v[184:185], v26 offset:53248
    ds_read_b64_tr_b16 v[186:187], v26 offset:55296
    v_mfma_f32_32x32x16_bf16 v[240:255], v[188:191], v[124:127], v[240:255]
    ds_read_b64_tr_b16 v[188:189], v27 offset:53248
    ds_read_b64_tr_b16 v[190:191], v27 offset:55296
    s_cbranch_vccnz F_tr_u2
F_bk_u2:
    v_add_f32 v14, v14, v15
    s_waitcnt lgkmcnt(15)
    s_branch F_pg3
.p2align 12
F_isl3:
    s_setpc_b64 s[40:41]
    s_nop 0
F_pg3:
    v_mfma_f32_32x32x16_bf16 v[64:79], v[128:131], v[32:35], v[96:111]
    ds_read_b128 v[128:131], v16 offset:57344
    v_exp_f32 v2, v80
    v_exp_f32 v3, v81
    v_mfma_f32_32x32x16_bf16 v[64:79], v[132:135], v[36:39], v[64:79]
    ds_read_b128 v[132:135], v17 offset:57344
    v_exp_f32 v4, v82
    v_exp_f32 v5, v83
    v_add_f32 v15, v2, v3
    v_mfma_f32_32x32x16_bf16 v[64:79], v[136:139], v[40:43], v[64:79]
    ds_read_b128 v[136:139], v18 offset:57344
    v_cvt_pk_bf16_f32 v120, v2, v3
    v_exp_f32 v6, v84
    v_exp_f32 v7, v85
    v_mfma_f32_32x32x16_bf16 v[64:79], v[140:143], v[44:47], v[64:79]
    ds_read_b128 v[140:143], v19 offset:57344
    v_add_f32 v28, v4, v5
    v_cvt_pk_bf16_f32 v121, v4, v5
    v_exp_f32 v2, v86
    v_mfma_f32_32x32x16_bf16 v[64:79], v[144:147], v[48:51], v[64:79]
    ds_read_b128 v[144:147], v20 offset:57344
    v_exp_f32 v3, v87
    v_add_f32 v15, v15, v6
    v_add_f32 v28, v28, v7
    v_cvt_pk_bf16_f32 v122, v6, v7
    v_mfma_f32_32x32x16_bf16 v[64:79], v[148:151], v[52:55], v[64:79]
    ds_read_b128 v[148:151], v21 offset:57344
    v_exp_f32 v4, v88
    v_exp_f32 v5, v89
    v_add_f32 v15, v15, v2
    v_mfma_f32_32x32x16_bf16 v[64:79], v[152:155], v[56:59], v[64:79]
    ds_read_b128 v[152:155], v22 offset:57344
    v_add_f32 v28, v28, v3
    v_cvt_pk_bf16_f32 v123, v2, v3
    v_exp_f32 v6, v90
    v_mfma_f32_32x32x16_bf16 v[64:79], v[156:159], v[60:63], v[64:79]
    ds_read_b128 v[156:159], v23 offset:57344
    s_waitcnt lgkmcnt(8)
    v_exp_f32 v7, v91
    v_add_f32 v15, v15, v4
    v_add_f32 v28, v28, v5
    v_mfma_f32_32x32x16_bf16 v[192:207], v[160:163], v[112:115], v[192:207]
    ds_read_b64_tr_b16 v[160:161], v24 offset:57344
    ds_read_b64_tr_b16 v[162:163], v24 offset:59392
    v_cvt_pk_bf16_f32 v124, v4, v5
    v_exp_f32 v2, v92
    v_mfma_f32_32x32x16_bf16 v[208:223], v[164:167], v[112:115], v[208:223]
    ds_read_b64_tr_b16 v[164:165], v25 offset:57344
    ds_read_b64_tr_b16 v[166:167], v25 offset:59392
    v_exp_f32 v3, v93
    v_add_f32 v15, v15, v6
    v_add_f32 v28, v28, v7
    v_mfma_f32_32x32x16_bf16 v[224:239], v[168:171], v[112:115], v[224:239]
    ds_read_b64_tr_b16 v[168:169], v26 offset:57344
    ds_read_b64_tr_b16 v[170:171], v26 offset:59392
    v_cvt_pk_bf16_f32 v125, v6, v7
    v_exp_f32 v4, v94
    v_mfma_f32_32x32x16_bf16 v[240:255], v[172:175], v[112:115], v[240:255]
    ds_read_b64_tr_b16 v[172:173], v27 offset:57344
    ds_read_b64_tr_b16 v[174:175], v27 offset:59392
    v_exp_f32 v5, v95
    v_add_f32 v15, v15, v2
    v_add_f32 v28, v28, v3
    v_mfma_f32_32x32x16_bf16 v[192:207], v[176:179], v[116:119], v[192:207]
    ds_read_b64_tr_b16 v[176:177], v24 offset:61440
    ds_read_b64_tr_b16 v[178:179], v24 offset:63488
    v_cvt_pk_bf16_f32 v126, v2, v3
    v_add_f32 v15, v15, v4
    v_add_f32 v28, v28, v5
    v_cvt_pk_bf16_f32 v127, v4, v5
    v_mfma_f32_32x32x16_bf16 v[208:223], v[180:183], v[116:119], v[208:223]
    ds_read_b64_tr_b16 v[180:181], v25 offset:61440
    ds_read_b64_tr_b16 v[182:183], v25 offset:63488
    v_add_f32 v15, v15, v28
    v_cmp_lt_f32 vcc, s32, v15
    v_mfma_f32_32x32x16_bf16 v[224:239], v[184:187], v[116:119], v[224:239]
    ds_read_b64_tr_b16 v[184:185], v26 offset:61440
    ds_read_b64_tr_b16 v[186:187], v26 offset:63488
    v_mfma_f32_32x32x16_bf16 v[240:255], v[188:191], v[116:119], v[240:255]
    ds_read_b64_tr_b16 v[188:189], v27 offset:61440
    ds_read_b64_tr_b16 v[190:191], v27 offset:63488
    s_cbranch_vccnz F_tr_u3
F_bk_u3:
    v_add_f32 v14, v14, v15
    s_waitcnt lgkmcnt(15)
    v_mfma_f32_32x32x16_bf16 v[80:95], v[128:131], v[32:35], v[96:111]
    v_add_u32 v24, 65536, v24
    v_add_u32 v25, 65536, v25
    v_add_u32 v26, 65536, v26
    v_add_u32 v27, 65536, v27
    v_exp_f32 v2, v64
    v_mfma_f32_32x32x16_bf16 v[80:95], v[132:135], v[36:39], v[80:95]
    s_waitcnt lgkmcnt(0)
    s_barrier
    ds_read_b128 v[128:131], v16 offset:16384
    v_exp_f32 v3, v65
    v_mfma_f32_32x32x16_bf16 v[80:95], v[136:139], v[40:43], v[80:95]
    ds_read_b128 v[132:135], v17 offset:16384
    ds_read_b128 v[136:139], v18 offset:16384
    v_exp_f32 v4, v66
    v_exp_f32 v5, v67
    v_mfma_f32_32x32x16_bf16 v[80:95], v[140:143], v[44:47], v[80:95]
    ds_read_b128 v[140:143], v19 offset:16384
    v_add_f32 v15, v2, v3
    v_cvt_pk_bf16_f32 v112, v2, v3
    v_exp_f32 v6, v68
    v_mfma_f32_32x32x16_bf16 v[80:95], v[144:147], v[48:51], v[80:95]
    ds_read_b128 v[144:147], v20 offset:16384
    v_exp_f32 v7, v69
    v_add_f32 v28, v4, v5
    v_cvt_pk_bf16_f32 v113, v4, v5
    v_mfma_f32_32x32x16_bf16 v[80:95], v[148:151], v[52:55], v[80:95]
    ds_read_b128 v[148:151], v21 offset:16384
    v_exp_f32 v2, v70
    v_exp_f32 v3, v71
    v_add_f32 v15, v15, v6
    v_mfma_f32_32x32x16_bf16 v[80:95], v[152:155], v[56:59], v[80:95]
    ds_read_b128 v[152:155], v22 offset:16384
    v_add_f32 v28, v28, v7
    v_cvt_pk_bf16_f32 v114, v6, v7
    v_exp_f32 v4, v72
    v_mfma_f32_32x32x16_bf16 v[80:95], v[156:159], v[60:63], v[80:95]
    ds_read_b128 v[156:159], v23 offset:16384
    v_exp_f32 v5, v73
    v_add_f32 v15, v15, v2
    v_add_f32 v28, v28, v3
    v_cvt_pk_bf16_f32 v115, v2, v3
    v_mfma_f32_32x32x16_bf16 v[192:207], v[160:163], v[120:123], v[192:207]
    ds_read_b64_tr_b16 v[160:161], v24 offset:16384
    ds_read_b64_tr_b16 v[162:163], v24 offset:18432
    v_exp_f32 v6, v74
    v_exp_f32 v7, v75
    v_mfma_f32_32x32x16_bf16 v[208:223], v[164:167], v[120:123], v[208:223]
    ds_read_b64_tr_b16 v[164:165], v25 offset:16384
    ds_read_b64_tr_b16 v[166:167], v25 offset:18432
    v_add_f32 v15, v15, v4
    v_add_f32 v28, v28, v5
    v_cvt_pk_bf16_f32 v116, v4, v5
    v_mfma_f32_32x32x16_bf16 v[224:239], v[168:171], v[120:123], v[224:239]
    ds_read_b64_tr_b16 v[168:169], v26 offset:16384
    ds_read_b64_tr_b16 v[170:171], v26 offset:18432
    v_exp_f32 v2, v76
    v_exp_f32 v3, v77
    v_mfma_f32_32x32x16_bf16 v[240:255], v[172:175], v[120:123], v[240:255]
    ds_read_b64_tr_b16 v[172:173], v27 offset:16384
    ds_read_b64_tr_b16 v[174:175], v27 offset:18432
    v_add_f32 v15, v15, v6
    v_add_f32 v28, v28, v7
    v_cvt_pk_bf16_f32 v117, v6, v7
    v_mfma_f32_32x32x16_bf16 v[192:207], v[176:179], v[124:127], v[192:207]
    ds_read_b64_tr_b16 v[176:177], v24 offset:20480
    ds_read_b64_tr_b16 v[178:179], v24 offset:22528
    v_exp_f32 v4, v78
    v_exp_f32 v5, v79
    v_mfma_f32_32x32x16_bf16 v[208:223], v[180:183], v[124:127], v[208:223]
    ds_read_b64_tr_b16 v[180:181], v25 offset:20480
    ds_read_b64_tr_b16 v[182:183], v25 offset:22528
    v_add_f32 v15, v15, v2
    v_add_f32 v28, v28, v3
    v_cvt_pk_bf16_f32 v118, v2, v3
    v_add_f32 v15, v15, v4
    v_mfma_f32_32x32x16_bf16 v[224:239], v[184:187], v[124:127], v[224:239]
    ds_read_b64_tr_b16 v[184:185], v26 offset:20480
    ds_read_b64_tr_b16 v[186:187], v26 offset:22528
    v_add_f32 v28, v28, v5
    v_cvt_pk_bf16_f32 v119, v4, v5
    v_add_f32 v15, v15, v28
    v_cmp_lt_f32 vcc, s32, v15
    v_mfma_f32_32x32x16_bf16 v[240:255], v[188:191], v[124:127], v[240:255]
    ds_read_b64_tr_b16 v[188:189], v27 offset:20480
    ds_read_b64_tr_b16 v[190:191], v27 offset:22528
    s_cbranch_vccnz F_tr_u4
F_bk_u4:
    v_add_f32 v14, v14, v15
    s_waitcnt lgkmcnt(15)
    v_mfma_f32_32x32x16_bf16 v[64:79], v[128:131], v[32:35], v[96:111]
    ds_read_b128 v[128:131], v16 offset:24576
    v_exp_f32 v2, v80
    v_exp_f32 v3, v81
    v_exp_f32 v4, v82
    v_mfma_f32_32x32x16_bf16 v[64:79], v[132:135], v[36:39], v[64:79]
    ds_read_b128 v[132:135], v17 offset:24576
    v_exp_f32 v5, v83
    v_add_f32 v15, v2, v3
    v_cvt_pk_bf16_f32 v120, v2, v3
    v_exp_f32 v6, v84
    v_mfma_f32_32x32x16_bf16 v[64:79], v[136:139], v[40:43], v[64:79]
    ds_read_b128 v[136:139], v18 offset:24576
    v_exp_f32 v7, v85
    v_add_f32 v28, v4, v5
    v_cvt_pk_bf16_f32 v121, v4, v5
    v_exp_f32 v2, v86
    v_mfma_f32_32x32x16_bf16 v[64:79], v[140:143], v[44:47], v[64:79]
    ds_read_b128 v[140:143], v19 offset:24576
    v_exp_f32 v3, v87
    v_add_f32 v15, v15, v6
    v_add_f32 v28, v28, v7
    v_cvt_pk_bf16_f32 v122, v6, v7
    v_mfma_f32_32x32x16_bf16 v[64:79], v[144:147], v[48:51], v[64:79]
    ds_read_b128 v[144:147], v20 offset:24576
    v_exp_f32 v4, v88
    v_exp_f32 v5, v89
    v_add_f32 v15, v15, v2
    v_add_f32 v28, v28, v3
    v_mfma_f32_32x32x16_bf16 v[64:79], v[148:151], v[52:55], v[64:79]
    ds_read_b128 v[148:151], v21 offset:24576
    v_cvt_pk_bf16_f32 v123, v2, v3
    v_exp_f32 v6, v90
    v_exp_f32 v7, v91
    v_add_f32 v15, v15, v4
    v_mfma_f32_32x32x16_bf16 v[64:79], v[152:155], v[56:59], v[64:79]
    ds_read_b128 v[152:155], v22 offset:24576
    v_add_f32 v28, v28, v5
    v_cvt_pk_bf16_f32 v124, v4, v5
    v_exp_f32 v2, v92
    v_exp_f32 v3, v93
    v_mfma_f32_32x32x16_bf16 v[64:79], v[156:159], v[60:63], v[64:79]
    ds_read_b128 v[156:159], v23 offset:24576
    s_waitcnt lgkmcnt(8)
    v_add_f32 v15, v15, v6
    v_add_f32 v28, v28, v7
    v_cvt_pk_bf16_f32 v125, v6, v7
    v_exp_f32 v4, v94
    v_mfma_f32_32x32x16_bf16 v[192:207], v[160:163], v[112:115], v[192:207]
    ds_read_b64_tr_b16 v[160:161], v24 offset:24576
    ds_read_b64_tr_b16 v[162:163], v24 offset:26624
    v_exp_f32 v5, v95
    v_add_f32 v15, v15, v2
    v_add_f32 v28, v28, v3
    v_cvt_pk_bf16_f32 v126, v2, v3
    v_mfma_f32_32x32x16_bf16 v[208:223], v[164:167], v[112:115], v[208:223]
    ds_read_b64_tr_b16 v[164:165], v25 offset:24576
    ds_read_b64_tr_b16 v[166:167], v25 offset:26624
    v_add_f32 v15, v15, v4
    v_add_f32 v28, v28, v5
    v_cvt_pk_bf16_f32 v127, v4, v5
    v_add_f32 v15, v15, v28
    v_cmp_lt_f32 vcc, s32, v15
    v_mfma_f32_32x32x16_bf16 v[224:239], v[168:171], v[112:115], v[224:239]
    ds_read_b64_tr_b16 v[168:169], v26 offset:24576
    ds_read_b64_tr_b16 v[170:171], v26 offset:26624
    v_add_u32 v23, 98304, v23
    v_mfma_f32_32x32x16_bf16 v[240:255], v[172:175], v[112:115], v[240:255]
    ds_read_b64_tr_b16 v[172:173], v27 offset:24576
    ds_read_b64_tr_b16 v[174:175], v27 offset:26624
    v_add_u32 v22, 98304, v22
    v_mfma_f32_32x32x16_bf16 v[192:207], v[176:179], v[116:119], v[192:207]
    ds_read_b64_tr_b16 v[176:177], v24 offset:28672
    ds_read_b64_tr_b16 v[178:179], v24 offset:30720
    v_add_u32 v21, 98304, v21
    v_mfma_f32_32x32x16_bf16 v[208:223], v[180:183], v[116:119], v[208:223]
    ds_read_b64_tr_b16 v[180:181], v25 offset:28672
    ds_read_b64_tr_b16 v[182:183], v25 offset:30720
    v_add_u32 v16, 98304, v16
    v_add_u32 v17, 98304, v17
    v_mfma_f32_32x32x16_bf16 v[224:239], v[184:187], v[116:119], v[224:239]
    ds_read_b64_tr_b16 v[184:185], v26 offset:28672
    ds_read_b64_tr_b16 v[186:187], v26 offset:30720
    v_add_u32 v18, 98304, v18
    v_add_u32 v19, 98304, v19
    v_add_u32 v20, 98304, v20
    v_mfma_f32_32x32x16_bf16 v[240:255], v[188:191], v[116:119], v[240:255]
    ds_read_b64_tr_b16 v[188:189], v27 offset:28672
    ds_read_b64_tr_b16 v[190:191], v27 offset:30720
    s_cbranch_vccnz F_tr_u5
F_bk_u5:
    v_add_f32 v14, v14, v15
    s_waitcnt lgkmcnt(15)
    v_mfma_f32_32x32x16_bf16 v[80:95], v[128:131], v[32:35], v[96:111]
    v_exp_f32 v2, v64
    v_exp_f32 v3, v65
    v_exp_f32 v4, v66
    v_mfma_f32_32x32x16_bf16 v[80:95], v[132:135], v[36:39], v[80:95]
    s_waitcnt lgkmcnt(0)
    s_barrier
    ds_read_b128 v[128:131], v16 offset:16384
    v_exp_f32 v5, v67
    v_add_f32 v15, v2, v3
    v_mfma_f32_32x32x16_bf16 v[80:95], v[136:139], v[40:43], v[80:95]
    ds_read_b128 v[132:135], v17 offset:16384
    ds_read_b128 v[136:139], v18 offset:16384
    v_cvt_pk_bf16_f32 v112, v2, v3
    v_exp_f32 v6, v68
    v_mfma_f32_32x32x16_bf16 v[80:95], v[140:143], v[44:47], v[80:95]
    ds_read_b128 v[140:143], v19 offset:16384
    v_exp_f32 v7, v69
    v_add_f32 v28, v4, v5
    v_cvt_pk_bf16_f32 v113, v4, v5
    v_mfma_f32_32x32x16_bf16 v[80:95], v[144:147], v[48:51], v[80:95]
    ds_read_b128 v[144:147], v20 offset:16384
    v_exp_f32 v2, v70
    v_exp_f32 v3, v71
    v_add_f32 v15, v15, v6
    v_mfma_f32_32x32x16_bf16 v[80:95], v[148:151], v[52:55], v[80:95]
    ds_read_b128 v[148:151], v21 offset:16384
    v_add_f32 v28, v28, v7
    v_cvt_pk_bf16_f32 v114, v6, v7
    v_exp_f32 v4, v72
    v_mfma_f32_32x32x16_bf16 v[80:95], v[152:155], v[56:59], v[80:95]
    ds_read_b128 v[152:155], v22 offset:16384
    v_exp_f32 v5, v73
    v_add_f32 v15, v15, v2
    v_add_f32 v28, v28, v3
    v_cvt_pk_bf16_f32 v115, v2, v3
    v_mfma_f32_32x32x16_bf16 v[80:95], v[156:159], v[60:63], v[80:95]
    ds_read_b128 v[156:159], v23 offset:16384
    v_exp_f32 v6, v74
    v_exp_f32 v7, v75
    v_add_f32 v15, v15, v4
    v_mfma_f32_32x32x16_bf16 v[192:207], v[160:163], v[120:123], v[192:207]
    ds_read_b64_tr_b16 v[160:161], v24 offset:49152
    ds_read_b64_tr_b16 v[162:163], v24 offset:51200
    v_add_f32 v28, v28, v5
    v_cvt_pk_bf16_f32 v116, v4, v5
    v_exp_f32 v2, v76
    v_mfma_f32_32x32x16_bf16 v[208:223], v[164:167], v[120:123], v[208:223]
    ds_read_b64_tr_b16 v[164:165], v25 offset:49152
    ds_read_b64_tr_b16 v[166:167], v25 offset:51200
    v_exp_f32 v3, v77
    v_add_f32 v15, v15, v6
    v_add_f32 v28, v28, v7
    v_mfma_f32_32x32x16_bf16 v[224:239], v[168:171], v[120:123], v[224:239]
    ds_read_b64_tr_b16 v[168:169], v26 offset:49152
    ds_read_b64_tr_b16 v[170:171], v26 offset:51200
    v_cvt_pk_bf16_f32 v117, v6, v7
    v_exp_f32 v4, v78
    v_mfma_f32_32x32x16_bf16 v[240:255], v[172:175], v[120:123], v[240:255]
    ds_read_b64_tr_b16 v[172:173], v27 offset:49152
    ds_read_b64_tr_b16 v[174:175], v27 offset:51200
    v_exp_f32 v5, v79
    v_add_f32 v15, v15, v2
    v_add_f32 v28, v28, v3
    v_mfma_f32_32x32x16_bf16 v[192:207], v[176:179], v[124:127], v[192:207]
    ds_read_b64_tr_b16 v[176:177], v24 offset:53248
    ds_read_b64_tr_b16 v[178:179], v24 offset:55296
    v_cvt_pk_bf16_f32 v118, v2, v3
    v_add_f32 v15, v15, v4
    v_add_f32 v28, v28, v5
    v_cvt_pk_bf16_f32 v119, v4, v5
    v_mfma_f32_32x32x16_bf16 v[208:223], v[180:183], v[124:127], v[208:223]
    ds_read_b64_tr_b16 v[180:181], v25 offset:53248
    ds_read_b64_tr_b16 v[182:183], v25 offset:55296
    v_add_f32 v15, v15, v28
    v_cmp_lt_f32 vcc, s32, v15
    v_mfma_f32_32x32x16_bf16 v[224:239], v[184:187], v[124:127], v[224:239]
    ds_read_b64_tr_b16 v[184:185], v26 offset:53248
    ds_read_b64_tr_b16 v[186:187], v26 offset:55296
    v_mfma_f32_32x32x16_bf16 v[240:255], v[188:191], v[124:127], v[240:255]
    ds_read_b64_tr_b16 v[188:189], v27 offset:53248
    ds_read_b64_tr_b16 v[190:191], v27 offset:55296
    s_cbranch_vccnz F_tr_u6
F_bk_u6:
    v_add_f32 v14, v14, v15
    s_waitcnt lgkmcnt(15)
    v_mfma_f32_32x32x16_bf16 v[64:79], v[128:131], v[32:35], v[96:111]
    ds_read_b128 v[128:131], v16 offset:24576
    v_exp_f32 v2, v80
    v_exp_f32 v3, v81
    v_mfma_f32_32x32x16_bf16 v[64:79], v[132:135], v[36:39], v[64:79]
    ds_read_b128 v[132:135], v17 offset:24576
    v_exp_f32 v4, v82
    v_exp_f32 v5, v83
    v_add_f32 v15, v2, v3
    v_mfma_f32_32x32x16_bf16 v[64:79], v[136:139], v[40:43], v[64:79]
    ds_read_b128 v[136:139], v18 offset:24576
    v_cvt_pk_bf16_f32 v120, v2, v3
    v_exp_f32 v6, v84
    v_exp_f32 v7, v85
    v_mfma_f32_32x32x16_bf16 v[64:79], v[140:143], v[44:47], v[64:79]
    ds_read_b128 v[140:143], v19 offset:24576
    v_add_f32 v28, v4, v5
    v_cvt_pk_bf16_f32 v121, v4, v5
    v_exp_f32 v2, v86
    v_mfma_f32_32x32x16_bf16 v[64:79], v[144:147], v[48:51], v[64:79]
    ds_read_b128 v[144:147], v20 offset:24576
    v_exp_f32 v3, v87
    v_add_f32 v15, v15, v6
    v_add_f32 v28, v28, v7
    v_cvt_pk_bf16_f32 v122, v6, v7
    v_mfma_f32_32x32x16_bf16 v[64:79], v[148:151], v[52:55], v[64:79]
    ds_read_b128 v[148:151], v21 offset:24576
    v_exp_f32 v4, v88
    v_exp_f32 v5, v89
    v_add_f32 v15, v15, v2
    v_mfma_f32_32x32x16_bf16 v[64:79], v[152:155], v[56:59], v[64:79]
    ds_read_b128 v[152:155], v22 offset:24576
    v_add_f32 v28, v28, v3
    v_cvt_pk_bf16_f32 v123, v2, v3
    v_exp_f32 v6, v90
    v_mfma_f32_32x32x16_bf16 v[64:79], v[156:159], v[60:63], v[64:79]
    ds_read_b128 v[156:159], v23 offset:24576
    s_waitcnt lgkmcnt(8)
    v_exp_f32 v7, v91
    v_add_f32 v15, v15, v4
    v_add_f32 v28, v28, v5
    v_mfma_f32_32x32x16_bf16 v[192:207], v[160:163], v[112:115], v[192:207]
    ds_read_b64_tr_b16 v[160:161], v24 offset:57344
    ds_read_b64_tr_b16 v[162:163], v24 offset:59392
    v_cvt_pk_bf16_f32 v124, v4, v5
    v_exp_f32 v2, v92
    v_mfma_f32_32x32x16_bf16 v[208:223], v[164:167], v[112:115], v[208:223]
    ds_read_b64_tr_b16 v[164:165], v25 offset:57344
    ds_read_b64_tr_b16 v[166:167], v25 offset:59392
    v_exp_f32 v3, v93
    v_add_f32 v15, v15, v6
    v_add_f32 v28, v28, v7
    v_mfma_f32_32x32x16_bf16 v[224:239], v[168:171], v[112:115], v[224:239]
    ds_read_b64_tr_b16 v[168:169], v26 offset:57344
    ds_read_b64_tr_b16 v[170:171], v26 offset:59392
    v_cvt_pk_bf16_f32 v125, v6, v7
    v_exp_f32 v4, v94
    v_mfma_f32_32x32x16_bf16 v[240:255], v[172:175], v[112:115], v[240:255]
    ds_read_b64_tr_b16 v[172:173], v27 offset:57344
    ds_read_b64_tr_b16 v[174:175], v27 offset:59392
    v_exp_f32 v5, v95
    v_add_f32 v15, v15, v2
    v_add_f32 v28, v28, v3
    v_mfma_f32_32x32x16_bf16 v[192:207], v[176:179], v[116:119], v[192:207]
    ds_read_b64_tr_b16 v[176:177], v24 offset:61440
    ds_read_b64_tr_b16 v[178:179], v24 offset:63488
    v_cvt_pk_bf16_f32 v126, v2, v3
    v_add_f32 v15, v15, v4
    v_add_f32 v28, v28, v5
    v_cvt_pk_bf16_f32 v127, v4, v5
    v_mfma_f32_32x32x16_bf16 v[208:223], v[180:183], v[116:119], v[208:223]
    ds_read_b64_tr_b16 v[180:181], v25 offset:61440
    ds_read_b64_tr_b16 v[182:183], v25 offset:63488
    v_add_f32 v15, v15, v28
    v_cmp_lt_f32 vcc, s32, v15
    v_mfma_f32_32x32x16_bf16 v[224:239], v[184:187], v[116:119], v[224:239]
    ds_read_b64_tr_b16 v[184:185], v26 offset:61440
    ds_read_b64_tr_b16 v[186:187], v26 offset:63488
    v_mfma_f32_32x32x16_bf16 v[240:255], v[188:191], v[116:119], v[240:255]
    ds_read_b64_tr_b16 v[188:189], v27 offset:61440
    ds_read_b64_tr_b16 v[190:191], v27 offset:63488
    s_cbranch_vccnz F_tr_u7
F_bk_u7:
    v_add_f32 v14, v14, v15
    s_waitcnt lgkmcnt(15)
    v_mfma_f32_32x32x16_bf16 v[80:95], v[128:131], v[32:35], v[96:111]
    v_exp_f32 v2, v64
    v_exp_f32 v3, v65
    v_exp_f32 v4, v66
    v_mfma_f32_32x32x16_bf16 v[80:95], v[132:135], v[36:39], v[80:95]
    s_waitcnt lgkmcnt(0)
    s_barrier
    ds_read_b128 v[128:131], v16 offset:49152
    v_exp_f32 v5, v67
    v_add_f32 v15, v2, v3
    v_mfma_f32_32x32x16_bf16 v[80:95], v[136:139], v[40:43], v[80:95]
    ds_read_b128 v[132:135], v17 offset:49152
    ds_read_b128 v[136:139], v18 offset:49152
    v_cvt_pk_bf16_f32 v112, v2, v3
    v_exp_f32 v6, v68
    v_mfma_f32_32x32x16_bf16 v[80:95], v[140:143], v[44:47], v[80:95]
    ds_read_b128 v[140:143], v19 offset:49152
    v_exp_f32 v7, v69
    v_add_f32 v28, v4, v5
    v_cvt_pk_bf16_f32 v113, v4, v5
    v_mfma_f32_32x32x16_bf16 v[80:95], v[144:147], v[48:51], v[80:95]
    ds_read_b128 v[144:147], v20 offset:49152
    v_exp_f32 v2, v70
    v_exp_f32 v3, v71
    v_add_f32 v15, v15, v6
    v_mfma_f32_32x32x16_bf16 v[80:95], v[148:151], v[52:55], v[80:95]
    ds_read_b128 v[148:151], v21 offset:49152
    v_add_f32 v28, v28, v7
    v_cvt_pk_bf16_f32 v114, v6, v7
    v_exp_f32 v4, v72
    v_mfma_f32_32x32x16_bf16 v[80:95], v[152:155], v[56:59], v[80:95]
    ds_read_b128 v[152:155], v22 offset:49152
    v_exp_f32 v5, v73
    v_add_f32 v15, v15, v2
    v_add_f32 v28, v28, v3
    v_cvt_pk_bf16_f32 v115, v2, v3
    v_mfma_f32_32x32x16_bf16 v[80:95], v[156:159], v[60:63], v[80:95]
    ds_read_b128 v[156:159], v23 offset:49152
    v_exp_f32 v6, v74
    v_exp_f32 v7, v75
    v_add_f32 v15, v15, v4
    v_mfma_f32_32x32x16_bf16 v[192:207], v[160:163], v[120:123], v[192:207]
    ds_read_b64_tr_b16 v[160:161], v24 offset:0
    ds_read_b64_tr_b16 v[162:163], v24 offset:2048
    v_add_f32 v28, v28, v5
    v_cvt_pk_bf16_f32 v116, v4, v5
    v_exp_f32 v2, v76
    v_mfma_f32_32x32x16_bf16 v[208:223], v[164:167], v[120:123], v[208:223]
    ds_read_b64_tr_b16 v[164:165], v25 offset:0
    ds_read_b64_tr_b16 v[166:167], v25 offset:2048
    v_exp_f32 v3, v77
    v_add_f32 v15, v15, v6
    v_add_f32 v28, v28, v7
    v_mfma_f32_32x32x16_bf16 v[224:239], v[168:171], v[120:123], v[224:239]
    ds_read_b64_tr_b16 v[168:169], v26 offset:0
    ds_read_b64_tr_b16 v[170:171], v26 offset:2048
    v_cvt_pk_bf16_f32 v117, v6, v7
    v_exp_f32 v4, v78
    v_mfma_f32_32x32x16_bf16 v[240:255], v[172:175], v[120:123], v[240:255]
    ds_read_b64_tr_b16 v[172:173], v27 offset:0
    ds_read_b64_tr_b16 v[174:175], v27 offset:2048
    v_exp_f32 v5, v79
    v_add_f32 v15, v15, v2
    v_add_f32 v28, v28, v3
    v_mfma_f32_32x32x16_bf16 v[192:207], v[176:179], v[124:127], v[192:207]
    ds_read_b64_tr_b16 v[176:177], v24 offset:4096
    ds_read_b64_tr_b16 v[178:179], v24 offset:6144
    v_cvt_pk_bf16_f32 v118, v2, v3
    v_add_f32 v15, v15, v4
    v_add_f32 v28, v28, v5
    v_cvt_pk_bf16_f32 v119, v4, v5
    v_mfma_f32_32x32x16_bf16 v[208:223], v[180:183], v[124:127], v[208:223]
    ds_read_b64_tr_b16 v[180:181], v25 offset:4096
    ds_read_b64_tr_b16 v[182:183], v25 offset:6144
    v_add_f32 v15, v15, v28
    v_cmp_lt_f32 vcc, s32, v15
    v_mfma_f32_32x32x16_bf16 v[224:239], v[184:187], v[124:127], v[224:239]
    ds_read_b64_tr_b16 v[184:185], v26 offset:4096
    ds_read_b64_tr_b16 v[186:187], v26 offset:6144
    v_mfma_f32_32x32x16_bf16 v[240:255], v[188:191], v[124:127], v[240:255]
    ds_read_b64_tr_b16 v[188:189], v27 offset:4096
    ds_read_b64_tr_b16 v[190:191], v27 offset:6144
    s_cbranch_vccnz F_tr_u8
F_bk_u8:
    v_add_f32 v14, v14, v15
    s_waitcnt lgkmcnt(15)
    v_mfma_f32_32x32x16_bf16 v[64:79], v[128:131], v[32:35], v[96:111]
    ds_read_b128 v[128:131], v16 offset:57344
    v_exp_f32 v2, v80
    v_exp_f32 v3, v81
    v_exp_f32 v4, v82
    v_mfma_f32_32x32x16_bf16 v[64:79], v[132:135], v[36:39], v[64:79]
    ds_read_b128 v[132:135], v17 offset:57344
    v_exp_f32 v5, v83
    v_add_f32 v15, v2, v3
    v_cvt_pk_bf16_f32 v120, v2, v3
    v_exp_f32 v6, v84
    v_mfma_f32_32x32x16_bf16 v[64:79], v[136:139], v[40:43], v[64:79]
    ds_read_b128 v[136:139], v18 offset:57344
    v_exp_f32 v7, v85
    v_add_f32 v28, v4, v5
    v_cvt_pk_bf16_f32 v121, v4, v5
    v_exp_f32 v2, v86
    v_mfma_f32_32x32x16_bf16 v[64:79], v[140:143], v[44:47], v[64:79]
    ds_read_b128 v[140:143], v19 offset:57344
    v_exp_f32 v3, v87
    v_add_f32 v15, v15, v6
    v_add_f32 v28, v28, v7
    v_cvt_pk_bf16_f32 v122, v6, v7
    v_mfma_f32_32x32x16_bf16 v[64:79], v[144:147], v[48:51], v[64:79]
    ds_read_b128 v[144:147], v20 offset:57344
    v_exp_f32 v4, v88
    v_exp_f32 v5, v89
    v_add_f32 v15, v15, v2
    v_add_f32 v28, v28, v3
    v_mfma_f32_32x32x16_bf16 v[64:79], v[148:151], v[52:55], v[64:79]
    ds_read_b128 v[148:151], v21 offset:57344
    v_cvt_pk_bf16_f32 v123, v2, v3
    v_exp_f32 v6, v90
    v_exp_f32 v7, v91
    v_add_f32 v15, v15, v4
    v_mfma_f32_32x32x16_bf16 v[64:79], v[152:155], v[56:59], v[64:79]
    ds_read_b128 v[152:155], v22 offset:57344
    v_add_f32 v28, v28, v5
    v_cvt_pk_bf16_f32 v124, v4, v5
    v_exp_f32 v2, v92
    v_exp_f32 v3, v93
    v_mfma_f32_32x32x16_bf16 v[64:79], v[156:159], v[60:63], v[64:79]
    ds_read_b128 v[156:159], v23 offset:57344
    s_waitcnt lgkmcnt(8)
    v_add_f32 v15, v15, v6
    v_add_f32 v28, v28, v7
    v_cvt_pk_bf16_f32 v125, v6, v7
    v_exp_f32 v4, v94
    v_mfma_f32_32x32x16_bf16 v[192:207], v[160:163], v[112:115], v[192:207]
    ds_read_b64_tr_b16 v[160:161], v24 offset:8192
    ds_read_b64_tr_b16 v[162:163], v24 offset:10240
    v_exp_f32 v5, v95
    v_add_f32 v15, v15, v2
    v_add_f32 v28, v28, v3
    v_cvt_pk_bf16_f32 v126, v2, v3
    v_mfma_f32_32x32x16_bf16 v[208:223], v[164:167], v[112:115], v[208:223]
    ds_read_b64_tr_b16 v[164:165], v25 offset:8192
    ds_read_b64_tr_b16 v[166:167], v25 offset:10240
    v_add_f32 v15, v15, v4
    v_add_f32 v28, v28, v5
    v_cvt_pk_bf16_f32 v127, v4, v5
    v_add_f32 v15, v15, v28
    v_cmp_lt_f32 vcc, s32, v15
    v_mfma_f32_32x32x16_bf16 v[224:239], v[168:171], v[112:115], v[224:239]
    ds_read_b64_tr_b16 v[168:169], v26 offset:8192
    ds_read_b64_tr_b16 v[170:171], v26 offset:10240
    v_add_u32 v23, 4294868992, v23
    v_mfma_f32_32x32x16_bf16 v[240:255], v[172:175], v[112:115], v[240:255]
    ds_read_b64_tr_b16 v[172:173], v27 offset:8192
    ds_read_b64_tr_b16 v[174:175], v27 offset:10240
    v_add_u32 v22, 4294868992, v22
    v_mfma_f32_32x32x16_bf16 v[192:207], v[176:179], v[116:119], v[192:207]
    ds_read_b64_tr_b16 v[176:177], v24 offset:12288
    ds_read_b64_tr_b16 v[178:179], v24 offset:14336
    v_add_u32 v21, 4294868992, v21
    v_mfma_f32_32x32x16_bf16 v[208:223], v[180:183], v[116:119], v[208:223]
    ds_read_b64_tr_b16 v[180:181], v25 offset:12288
    ds_read_b64_tr_b16 v[182:183], v25 offset:14336
    v_add_u32 v16, 4294868992, v16
    v_add_u32 v17, 4294868992, v17
    v_mfma_f32_32x32x16_bf16 v[224:239], v[184:187], v[116:119], v[224:239]
    ds_read_b64_tr_b16 v[184:185], v26 offset:12288
    ds_read_b64_tr_b16 v[186:187], v26 offset:14336
    v_add_u32 v18, 4294868992, v18
    v_add_u32 v19, 4294868992, v19
    v_add_u32 v20, 4294868992, v20
    v_mfma_f32_32x32x16_bf16 v[240:255], v[188:191], v[116:119], v[240:255]
    ds_read_b64_tr_b16 v[188:189], v27 offset:12288
    ds_read_b64_tr_b16 v[190:191], v27 offset:14336
    s_cbranch_vccnz F_tr_u9
F_bk_u9:
    v_add_f32 v14, v14, v15
    s_waitcnt lgkmcnt(15)
    s_branch F_pg10
.p2align 12
F_isl10:
    s_setpc_b64 s[40:41]
    s_nop 0
F_pg10:
    v_mfma_f32_32x32x16_bf16 v[80:95], v[128:131], v[32:35], v[96:111]
    v_add_u32 v24, 4294901760, v24
    v_add_u32 v25, 4294901760, v25
    v_add_u32 v26, 4294901760, v26
    v_add_u32 v27, 4294901760, v27
    v_exp_f32 v2, v64
    v_mfma_f32_32x32x16_bf16 v[80:95], v[132:135], v[36:39], v[80:95]
    s_waitcnt lgkmcnt(0)
    s_barrier
    ds_read_b128 v[128:131], v16 offset:0
    v_exp_f32 v3, v65
    v_mfma_f32_32x32x16_bf16 v[80:95], v[136:139], v[40:43], v[80:95]
    ds_read_b128 v[132:135], v17 offset:0
    ds_read_b128 v[136:139], v18 offset:0
    v_exp_f32 v4, v66
    v_exp_f32 v5, v67
    v_mfma_f32_32x32x16_bf16 v[80:95], v[140:143], v[44:47], v[80:95]
    ds_read_b128 v[140:143], v19 offset:0
    v_add_f32 v15, v2, v3
    v_cvt_pk_bf16_f32 v112, v2, v3
    v_exp_f32 v6, v68
    v_mfma_f32_32x32x16_bf16 v[80:95], v[144:147], v[48:51], v[80:95]
    ds_read_b128 v[144:147], v20 offset:0
    v_exp_f32 v7, v69
    v_add_f32 v28, v4, v5
    v_cvt_pk_bf16_f32 v113, v4, v5
    v_mfma_f32_32x32x16_bf16 v[80:95], v[148:151], v[52:55], v[80:95]
    ds_read_b128 v[148:151], v21 offset:0
    v_exp_f32 v2, v70
    v_exp_f32 v3, v71
    v_add_f32 v15, v15, v6
    v_mfma_f32_32x32x16_bf16 v[80:95], v[152:155], v[56:59], v[80:95]
    ds_read_b128 v[152:155], v22 offset:0
    v_add_f32 v28, v28, v7
    v_cvt_pk_bf16_f32 v114, v6, v7
    v_exp_f32 v4, v72
    v_mfma_f32_32x32x16_bf16 v[80:95], v[156:159], v[60:63], v[80:95]
    ds_read_b128 v[156:159], v23 offset:0
    v_exp_f32 v5, v73
    v_add_f32 v15, v15, v2
    v_add_f32 v28, v28, v3
    v_cvt_pk_bf16_f32 v115, v2, v3
    v_mfma_f32_32x32x16_bf16 v[192:207], v[160:163], v[120:123], v[192:207]
    ds_read_b64_tr_b16 v[160:161], v24 offset:49152
    ds_read_b64_tr_b16 v[162:163], v24 offset:51200
    v_exp_f32 v6, v74
    v_exp_f32 v7, v75
    v_mfma_f32_32x32x16_bf16 v[208:223], v[164:167], v[120:123], v[208:223]
    ds_read_b64_tr_b16 v[164:165], v25 offset:49152
    ds_read_b64_tr_b16 v[166:167], v25 offset:51200
    v_add_f32 v15, v15, v4
    v_add_f32 v28, v28, v5
    v_cvt_pk_bf16_f32 v116, v4, v5
    v_mfma_f32_32x32x16_bf16 v[224:239], v[168:171], v[120:123], v[224:239]
    ds_read_b64_tr_b16 v[168:169], v26 offset:49152
    ds_read_b64_tr_b16 v[170:171], v26 offset:51200
    v_exp_f32 v2, v76
    v_exp_f32 v3, v77
    v_mfma_f32_32x32x16_bf16 v[240:255], v[172:175], v[120:123], v[240:255]
    ds_read_b64_tr_b16 v[172:173], v27 offset:49152
    ds_read_b64_tr_b16 v[174:175], v27 offset:51200
    v_add_f32 v15, v15, v6
    v_add_f32 v28, v28, v7
    v_cvt_pk_bf16_f32 v117, v6, v7
    v_mfma_f32_32x32x16_bf16 v[192:207], v[176:179], v[124:127], v[192:207]
    ds_read_b64_tr_b16 v[176:177], v24 offset:53248
    ds_read_b64_tr_b16 v[178:179], v24 offset:55296
    v_exp_f32 v4, v78
    v_exp_f32 v5, v79
    v_mfma_f32_32x32x16_bf16 v[208:223], v[180:183], v[124:127], v[208:223]
    ds_read_b64_tr_b16 v[180:181], v25 offset:53248
    ds_read_b64_tr_b16 v[182:183], v25 offset:55296
    v_add_f32 v15, v15, v2
    v_add_f32 v28, v28, v3
    v_cvt_pk_bf16_f32 v118, v2, v3
    v_add_f32 v15, v15, v4
    v_mfma_f32_32x32x16_bf16 v[224:239], v[184:187], v[124:127], v[224:239]
    ds_read_b64_tr_b16 v[184:185], v26 offset:53248
    ds_read_b64_tr_b16 v[186:187], v26 offset:55296
    v_add_f32 v28, v28, v5
    v_cvt_pk_bf16_f32 v119, v4, v5
    v_add_f32 v15, v15, v28
    v_cmp_lt_f32 vcc, s32, v15
    v_mfma_f32_32x32x16_bf16 v[240:255], v[188:191], v[124:127], v[240:255]
    ds_read_b64_tr_b16 v[188:189], v27 offset:53248
    ds_read_b64_tr_b16 v[190:191], v27 offset:55296
    s_cbranch_vccnz F_tr_u10
F_bk_u10:
    v_add_f32 v14, v14, v15
    s_waitcnt lgkmcnt(15)
    v_mfma_f32_32x32x16_bf16 v[64:79], v[128:131], v[32:35], v[96:111]
    ds_read_b128 v[128:131], v16 offset:8192
    v_exp_f32 v2, v80
    v_exp_f32 v3, v81
    v_mfma_f32_32x32x16_bf16 v[64:79], v[132:135], v[36:39], v[64:79]
    ds_read_b128 v[132:135], v17 offset:8192
    v_exp_f32 v4, v82
    v_exp_f32 v5, v83
    v_add_f32 v15, v2, v3
    v_mfma_f32_32x32x16_bf16 v[64:79], v[136:139], v[40:43], v[64:79]
    ds_read_b128 v[136:139], v18 offset:8192
    v_cvt_pk_bf16_f32 v120, v2, v3
    v_exp_f32 v6, v84
    v_exp_f32 v7, v85
    v_mfma_f32_32x32x16_bf16 v[64:79], v[140:143], v[44:47], v[64:79]
    ds_read_b128 v[140:143], v19 offset:8192
    v_add_f32 v28, v4, v5
    v_cvt_pk_bf16_f32 v121, v4, v5
    v_exp_f32 v2, v86
    v_mfma_f32_32x32x16_bf16 v[64:79], v[144:147], v[48:51], v[64:79]
    ds_read_b128 v[144:147], v20 offset:8192
    v_exp_f32 v3, v87
    v_add_f32 v15, v15, v6
    v_add_f32 v28, v28, v7
    v_cvt_pk_bf16_f32 v122, v6, v7
    v_mfma_f32_32x32x16_bf16 v[64:79], v[148:151], v[52:55], v[64:79]
    ds_read_b128 v[148:151], v21 offset:8192
    v_exp_f32 v4, v88
    v_exp_f32 v5, v89
    v_add_f32 v15, v15, v2
    v_mfma_f32_32x32x16_bf16 v[64:79], v[152:155], v[56:59], v[64:79]
    ds_read_b128 v[152:155], v22 offset:8192
    v_add_f32 v28, v28, v3
    v_cvt_pk_bf16_f32 v123, v2, v3
    v_exp_f32 v6, v90
    v_mfma_f32_32x32x16_bf16 v[64:79], v[156:159], v[60:63], v[64:79]
    ds_read_b128 v[156:159], v23 offset:8192
    s_waitcnt lgkmcnt(8)
    v_exp_f32 v7, v91
    v_add_f32 v15, v15, v4
    v_add_f32 v28, v28, v5
    v_mfma_f32_32x32x16_bf16 v[192:207], v[160:163], v[112:115], v[192:207]
    ds_read_b64_tr_b16 v[160:161], v24 offset:57344
    ds_read_b64_tr_b16 v[162:163], v24 offset:59392
    v_cvt_pk_bf16_f32 v124, v4, v5
    v_exp_f32 v2, v92
    v_mfma_f32_32x32x16_bf16 v[208:223], v[164:167], v[112:115], v[208:223]
    ds_read_b64_tr_b16 v[164:165], v25 offset:57344
    ds_read_b64_tr_b16 v[166:167], v25 offset:59392
    v_exp_f32 v3, v93
    v_add_f32 v15, v15, v6
    v_add_f32 v28, v28, v7
    v_mfma_f32_32x32x16_bf16 v[224:239], v[168:171], v[112:115], v[224:239]
    ds_read_b64_tr_b16 v[168:169], v26 offset:57344
    ds_read_b64_tr_b16 v[170:171], v26 offset:59392
    v_cvt_pk_bf16_f32 v125, v6, v7
    v_exp_f32 v4, v94
    v_mfma_f32_32x32x16_bf16 v[240:255], v[172:175], v[112:115], v[240:255]
    ds_read_b64_tr_b16 v[172:173], v27 offset:57344
    ds_read_b64_tr_b16 v[174:175], v27 offset:59392
    v_exp_f32 v5, v95
    v_add_f32 v15, v15, v2
    v_add_f32 v28, v28, v3
    v_mfma_f32_32x32x16_bf16 v[192:207], v[176:179], v[116:119], v[192:207]
    ds_read_b64_tr_b16 v[176:177], v24 offset:61440
    ds_read_b64_tr_b16 v[178:179], v24 offset:63488
    v_cvt_pk_bf16_f32 v126, v2, v3
    v_add_f32 v15, v15, v4
    v_add_f32 v28, v28, v5
    v_cvt_pk_bf16_f32 v127, v4, v5
    v_mfma_f32_32x32x16_bf16 v[208:223], v[180:183], v[116:119], v[208:223]
    ds_read_b64_tr_b16 v[180:181], v25 offset:61440
    ds_read_b64_tr_b16 v[182:183], v25 offset:63488
    v_add_f32 v15, v15, v28
    v_cmp_lt_f32 vcc, s32, v15
    v_mfma_f32_32x32x16_bf16 v[224:239], v[184:187], v[116:119], v[224:239]
    ds_read_b64_tr_b16 v[184:185], v26 offset:61440
    ds_read_b64_tr_b16 v[186:187], v26 offset:63488
    v_mfma_f32_32x32x16_bf16 v[240:255], v[188:191], v[116:119], v[240:255]
    ds_read_b64_tr_b16 v[188:189], v27 offset:61440
    ds_read_b64_tr_b16 v[190:191], v27 offset:63488
    s_cbranch_vccnz F_tr_u11
F_bk_u11:
    v_add_f32 v14, v14, v15
    s_waitcnt lgkmcnt(15)
    v_mfma_f32_32x32x16_bf16 v[80:95], v[128:131], v[32:35], v[96:111]
    v_exp_f32 v2, v64
    v_exp_f32 v3, v65
    v_exp_f32 v4, v66
    v_mfma_f32_32x32x16_bf16 v[80:95], v[132:135], v[36:39], v[80:95]
    s_waitcnt lgkmcnt(0)
    s_barrier
    ds_read_b128 v[128:131], v16 offset:32768
    v_exp_f32 v5, v67
    v_add_f32 v15, v2, v3
    v_mfma_f32_32x32x16_bf16 v[80:95], v[136:139], v[40:43], v[80:95]
    ds_read_b128 v[132:135], v17 offset:32768
    ds_read_b128 v[136:139], v18 offset:32768
    v_cvt_pk_bf16_f32 v112, v2, v3
    v_exp_f32 v6, v68
    v_mfma_f32_32x32x16_bf16 v[80:95], v[140:143], v[44:47], v[80:95]
    ds_read_b128 v[140:143], v19 offset:32768
    v_exp_f32 v7, v69
    v_add_f32 v28, v4, v5
    v_cvt_pk_bf16_f32 v113, v4, v5
    v_mfma_f32_32x32x16_bf16 v[80:95], v[144:147], v[48:51], v[80:95]
    ds_read_b128 v[144:147], v20 offset:32768
    v_exp_f32 v2, v70
    v_exp_f32 v3, v71
    v_add_f32 v15, v15, v6
    v_mfma_f32_32x32x16_bf16 v[80:95], v[148:151], v[52:55], v[80:95]
    ds_read_b128 v[148:151], v21 offset:32768
    v_add_f32 v28, v28, v7
    v_cvt_pk_bf16_f32 v114, v6, v7
    v_exp_f32 v4, v72
    v_mfma_f32_32x32x16_bf16 v[80:95], v[152:155], v[56:59], v[80:95]
    ds_read_b128 v[152:155], v22 offset:32768
    v_exp_f32 v5, v73
    v_add_f32 v15, v15, v2
    v_add_f32 v28, v28, v3
    v_cvt_pk_bf16_f32 v115, v2, v3
    v_mfma_f32_32x32x16_bf16 v[80:95], v[156:159], v[60:63], v[80:95]
    ds_read_b128 v[156:159], v23 offset:32768
    v_exp_f32 v6, v74
    v_exp_f32 v7, v75
    v_add_f32 v15, v15, v4
    v_mfma_f32_32x32x16_bf16 v[192:207], v[160:163], v[120:123], v[192:207]
    ds_read_b64_tr_b16 v[160:161], v24 offset:32768
    ds_read_b64_tr_b16 v[162:163], v24 offset:34816
    v_add_f32 v28, v28, v5
    v_cvt_pk_bf16_f32 v116, v4, v5
    v_exp_f32 v2, v76
    v_mfma_f32_32x32x16_bf16 v[208:223], v[164:167], v[120:123], v[208:223]
    ds_read_b64_tr_b16 v[164:165], v25 offset:32768
    ds_read_b64_tr_b16 v[166:167], v25 offset:34816
    v_exp_f32 v3, v77
    v_add_f32 v15, v15, v6
    v_add_f32 v28, v28, v7
    v_mfma_f32_32x32x16_bf16 v[224:239], v[168:171], v[120:123], v[224:239]
    ds_read_b64_tr_b16 v[168:169], v26 offset:32768
    ds_read_b64_tr_b16 v[170:171], v26 offset:34816
    v_cvt_pk_bf16_f32 v117, v6, v7
    v_exp_f32 v4, v78
    v_mfma_f32_32x32x16_bf16 v[240:255], v[172:175], v[120:123], v[240:255]
    ds_read_b64_tr_b16 v[172:173], v27 offset:32768
    ds_read_b64_tr_b16 v[174:175], v27 offset:34816
    v_exp_f32 v5, v79
    v_add_f32 v15, v15, v2
    v_add_f32 v28, v28, v3
    v_mfma_f32_32x32x16_bf16 v[192:207], v[176:179], v[124:127], v[192:207]
    ds_read_b64_tr_b16 v[176:177], v24 offset:36864
    ds_read_b64_tr_b16 v[178:179], v24 offset:38912
    v_cvt_pk_bf16_f32 v118, v2, v3
    v_add_f32 v15, v15, v4
    v_add_f32 v28, v28, v5
    v_cvt_pk_bf16_f32 v119, v4, v5
    v_mfma_f32_32x32x16_bf16 v[208:223], v[180:183], v[124:127], v[208:223]
    ds_read_b64_tr_b16 v[180:181], v25 offset:36864
    ds_read_b64_tr_b16 v[182:183], v25 offset:38912
    v_add_f32 v15, v15, v28
    v_cmp_lt_f32 vcc, s32, v15
    v_mfma_f32_32x32x16_bf16 v[224:239], v[184:187], v[124:127], v[224:239]
    ds_read_b64_tr_b16 v[184:185], v26 offset:36864
    ds_read_b64_tr_b16 v[186:187], v26 offset:38912
    v_mfma_f32_32x32x16_bf16 v[240:255], v[188:191], v[124:127], v[240:255]
    ds_read_b64_tr_b16 v[188:189], v27 offset:36864
    ds_read_b64_tr_b16 v[190:191], v27 offset:38912
    s_cbranch_vccnz F_tr_u12
F_bk_u12:
    v_add_f32 v14, v14, v15
    s_waitcnt lgkmcnt(15)
    v_mfma_f32_32x32x16_bf16 v[64:79], v[128:131], v[32:35], v[96:111]
    ds_read_b128 v[128:131], v16 offset:40960
    v_exp_f32 v2, v80
    v_exp_f32 v3, v81
    v_mfma_f32_32x32x16_bf16 v[64:79], v[132:135], v[36:39], v[64:79]
    ds_read_b128 v[132:135], v17 offset:40960
    v_exp_f32 v4, v82
    v_exp_f32 v5, v83
    v_add_f32 v15, v2, v3
    v_mfma_f32_32x32x16_bf16 v[64:79], v[136:139], v[40:43], v[64:79]
    ds_read_b128 v[136:139], v18 offset:40960
    v_cvt_pk_bf16_f32 v120, v2, v3
    v_exp_f32 v6, v84
    v_exp_f32 v7, v85
    v_mfma_f32_32x32x16_bf16 v[64:79], v[140:143], v[44:47], v[64:79]
    ds_read_b128 v[140:143], v19 offset:40960
    v_add_f32 v28, v4, v5
    v_cvt_pk_bf16_f32 v121, v4, v5
    v_exp_f32 v2, v86
    v_mfma_f32_32x32x16_bf16 v[64:79], v[144:147], v[48:51], v[64:79]
    ds_read_b128 v[144:147], v20 offset:40960
    v_exp_f32 v3, v87
    v_add_f32 v15, v15, v6
    v_add_f32 v28, v28, v7
    v_cvt_pk_bf16_f32 v122, v6, v7
    v_mfma_f32_32x32x16_bf16 v[64:79], v[148:151], v[52:55], v[64:79]
    ds_read_b128 v[148:151], v21 offset:40960
    v_exp_f32 v4, v88
    v_exp_f32 v5, v89
    v_add_f32 v15, v15, v2
    v_mfma_f32_32x32x16_bf16 v[64:79], v[152:155], v[56:59], v[64:79]
    ds_read_b128 v[152:155], v22 offset:40960
    v_add_f32 v28, v28, v3
    v_cvt_pk_bf16_f32 v123, v2, v3
    v_exp_f32 v6, v90
    v_mfma_f32_32x32x16_bf16 v[64:79], v[156:159], v[60:63], v[64:79]
    ds_read_b128 v[156:159], v23 offset:40960
    s_waitcnt lgkmcnt(8)
    v_exp_f32 v7, v91
    v_add_f32 v15, v15, v4
    v_add_f32 v28, v28, v5
    v_mfma_f32_32x32x16_bf16 v[192:207], v[160:163], v[112:115], v[192:207]
    ds_read_b64_tr_b16 v[160:161], v24 offset:40960
    ds_read_b64_tr_b16 v[162:163], v24 offset:43008
    v_cvt_pk_bf16_f32 v124, v4, v5
    v_exp_f32 v2, v92
    v_mfma_f32_32x32x16_bf16 v[208:223], v[164:167], v[112:115], v[208:223]
    ds_read_b64_tr_b16 v[164:165], v25 offset:40960
    ds_read_b64_tr_b16 v[166:167], v25 offset:43008
    v_exp_f32 v3, v93
    v_add_f32 v15, v15, v6
    v_add_f32 v28, v28, v7
    v_mfma_f32_32x32x16_bf16 v[224:239], v[168:171], v[112:115], v[224:239]
    ds_read_b64_tr_b16 v[168:169], v26 offset:40960
    ds_read_b64_tr_b16 v[170:171], v26 offset:43008
    v_cvt_pk_bf16_f32 v125, v6, v7
    v_exp_f32 v4, v94
    v_mfma_f32_32x32x16_bf16 v[240:255], v[172:175], v[112:115], v[240:255]
    ds_read_b64_tr_b16 v[172:173], v27 offset:40960
    ds_read_b64_tr_b16 v[174:175], v27 offset:43008
    v_exp_f32 v5, v95
    v_add_f32 v15, v15, v2
    v_add_f32 v28, v28, v3
    v_mfma_f32_32x32x16_bf16 v[192:207], v[176:179], v[116:119], v[192:207]
    ds_read_b64_tr_b16 v[176:177], v24 offset:45056
    ds_read_b64_tr_b16 v[178:179], v24 offset:47104
    v_cvt_pk_bf16_f32 v126, v2, v3
    v_add_f32 v15, v15, v4
    v_add_f32 v28, v28, v5
    v_cvt_pk_bf16_f32 v127, v4, v5
    v_mfma_f32_32x32x16_bf16 v[208:223], v[180:183], v[116:119], v[208:223]
    ds_read_b64_tr_b16 v[180:181], v25 offset:45056
    ds_read_b64_tr_b16 v[182:183], v25 offset:47104
    v_add_f32 v15, v15, v28
    v_cmp_lt_f32 vcc, s32, v15
    v_mfma_f32_32x32x16_bf16 v[224:239], v[184:187], v[116:119], v[224:239]
    ds_read_b64_tr_b16 v[184:185], v26 offset:45056
    ds_read_b64_tr_b16 v[186:187], v26 offset:47104
    v_mfma_f32_32x32x16_bf16 v[240:255], v[188:191], v[116:119], v[240:255]
    ds_read_b64_tr_b16 v[188:189], v27 offset:45056
    ds_read_b64_tr_b16 v[190:191], v27 offset:47104
    s_cbranch_vccnz F_tr_u13
F_bk_u13:
    v_add_f32 v14, v14, v15
    s_waitcnt lgkmcnt(15)
    v_mfma_f32_32x32x16_bf16 v[80:95], v[128:131], v[32:35], v[96:111]
    v_exp_f32 v2, v64
    v_exp_f32 v3, v65
    v_exp_f32 v4, v66
    v_mfma_f32_32x32x16_bf16 v[80:95], v[132:135], v[36:39], v[80:95]
    s_waitcnt lgkmcnt(0)
    s_barrier
    v_exp_f32 v5, v67
    v_add_f32 v15, v2, v3
    v_cvt_pk_bf16_f32 v112, v2, v3
    v_mfma_f32_32x32x16_bf16 v[80:95], v[136:139], v[40:43], v[80:95]
    v_exp_f32 v6, v68
    v_exp_f32 v7, v69
    v_add_f32 v28, v4, v5
    v_cvt_pk_bf16_f32 v113, v4, v5
    v_mfma_f32_32x32x16_bf16 v[80:95], v[140:143], v[44:47], v[80:95]
    v_exp_f32 v2, v70
    v_exp_f32 v3, v71
    v_add_f32 v15, v15, v6
    v_add_f32 v28, v28, v7
    v_mfma_f32_32x32x16_bf16 v[80:95], v[144:147], v[48:51], v[80:95]
    v_cvt_pk_bf16_f32 v114, v6, v7
    v_exp_f32 v4, v72
    v_exp_f32 v5, v73
    v_add_f32 v15, v15, v2
    v_mfma_f32_32x32x16_bf16 v[80:95], v[148:151], v[52:55], v[80:95]
    v_add_f32 v28, v28, v3
    v_cvt_pk_bf16_f32 v115, v2, v3
    v_exp_f32 v6, v74
    v_exp_f32 v7, v75
    v_mfma_f32_32x32x16_bf16 v[80:95], v[152:155], v[56:59], v[80:95]
    v_add_f32 v15, v15, v4
    v_add_f32 v28, v28, v5
    v_cvt_pk_bf16_f32 v116, v4, v5
    v_exp_f32 v2, v76
    v_mfma_f32_32x32x16_bf16 v[80:95], v[156:159], v[60:63], v[80:95]
    v_exp_f32 v3, v77
    v_add_f32 v15, v15, v6
    v_add_f32 v28, v28, v7
    v_cvt_pk_bf16_f32 v117, v6, v7
    v_mfma_f32_32x32x16_bf16 v[192:207], v[160:163], v[120:123], v[192:207]
    ds_read_b64_tr_b16 v[160:161], v24 offset:0
    ds_read_b64_tr_b16 v[162:163], v24 offset:2048
    v_exp_f32 v4, v78
    v_exp_f32 v5, v79
    v_mfma_f32_32x32x16_bf16 v[208:223], v[164:167], v[120:123], v[208:223]
    ds_read_b64_tr_b16 v[164:165], v25 offset:0
    ds_read_b64_tr_b16 v[166:167], v25 offset:2048
    v_add_f32 v15, v15, v2
    v_add_f32 v28, v28, v3
    v_cvt_pk_bf16_f32 v118, v2, v3
    v_add_f32 v15, v15, v4
    v_mfma_f32_32x32x16_bf16 v[224:239], v[168:171], v[120:123], v[224:239]
    ds_read_b64_tr_b16 v[168:169], v26 offset:0
    ds_read_b64_tr_b16 v[170:171], v26 offset:2048
    v_add_f32 v28, v28, v5
    v_cvt_pk_bf16_f32 v119, v4, v5
    v_add_f32 v15, v15, v28
    v_cmp_lt_f32 vcc, s32, v15
    v_mfma_f32_32x32x16_bf16 v[240:255], v[172:175], v[120:123], v[240:255]
    ds_read_b64_tr_b16 v[172:173], v27 offset:0
    ds_read_b64_tr_b16 v[174:175], v27 offset:2048
    v_mfma_f32_32x32x16_bf16 v[192:207], v[176:179], v[124:127], v[192:207]
    ds_read_b64_tr_b16 v[176:177], v24 offset:4096
    ds_read_b64_tr_b16 v[178:179], v24 offset:6144
    v_mfma_f32_32x32x16_bf16 v[208:223], v[180:183], v[124:127], v[208:223]
    ds_read_b64_tr_b16 v[180:181], v25 offset:4096
    ds_read_b64_tr_b16 v[182:183], v25 offset:6144
    v_mfma_f32_32x32x16_bf16 v[224:239], v[184:187], v[124:127], v[224:239]
    ds_read_b64_tr_b16 v[184:185], v26 offset:4096
    ds_read_b64_tr_b16 v[186:187], v26 offset:6144
    v_mfma_f32_32x32x16_bf16 v[240:255], v[188:191], v[124:127], v[240:255]
    ds_read_b64_tr_b16 v[188:189], v27 offset:4096
    ds_read_b64_tr_b16 v[190:191], v27 offset:6144
    s_cbranch_vccnz F_tr_u14
F_bk_u14:
    v_add_f32 v14, v14, v15
    v_exp_f32 v2, v80
    v_exp_f32 v3, v81
    v_exp_f32 v4, v82
    v_exp_f32 v5, v83
    v_add_f32 v15, v2, v3
    v_cvt_pk_bf16_f32 v120, v2, v3
    s_waitcnt lgkmcnt(8)
    v_mfma_f32_32x32x16_bf16 v[192:207], v[160:163], v[112:115], v[192:207]
    ds_read_b64_tr_b16 v[160:161], v24 offset:8192
    ds_read_b64_tr_b16 v[162:163], v24 offset:10240
    v_exp_f32 v6, v84
    v_exp_f32 v7, v85
    v_add_f32 v28, v4, v5
    v_cvt_pk_bf16_f32 v121, v4, v5
    v_mfma_f32_32x32x16_bf16 v[208:223], v[164:167], v[112:115], v[208:223]
    ds_read_b64_tr_b16 v[164:165], v25 offset:8192
    ds_read_b64_tr_b16 v[166:167], v25 offset:10240
    v_exp_f32 v2, v86
    v_exp_f32 v3, v87
    v_add_f32 v15, v15, v6
    v_add_f32 v28, v28, v7
    v_cvt_pk_bf16_f32 v122, v6, v7
    v_mfma_f32_32x32x16_bf16 v[224:239], v[168:171], v[112:115], v[224:239]
    ds_read_b64_tr_b16 v[168:169], v26 offset:8192
    ds_read_b64_tr_b16 v[170:171], v26 offset:10240
    v_exp_f32 v4, v88
    v_exp_f32 v5, v89
    v_add_f32 v15, v15, v2
    v_add_f32 v28, v28, v3
    v_cvt_pk_bf16_f32 v123, v2, v3
    v_mfma_f32_32x32x16_bf16 v[240:255], v[172:175], v[112:115], v[240:255]
    ds_read_b64_tr_b16 v[172:173], v27 offset:8192
    ds_read_b64_tr_b16 v[174:175], v27 offset:10240
    s_waitcnt lgkmcnt(8)
    v_exp_f32 v6, v90
    v_exp_f32 v7, v91
    v_add_f32 v15, v15, v4
    v_add_f32 v28, v28, v5
    v_mfma_f32_32x32x16_bf16 v[192:207], v[176:179], v[116:119], v[192:207]
    ds_read_b64_tr_b16 v[176:177], v24 offset:12288
    ds_read_b64_tr_b16 v[178:179], v24 offset:14336
    v_cvt_pk_bf16_f32 v124, v4, v5
    v_exp_f32 v2, v92
    v_exp_f32 v3, v93
    v_add_f32 v15, v15, v6
    v_add_f32 v28, v28, v7
    v_mfma_f32_32x32x16_bf16 v[208:223], v[180:183], v[116:119], v[208:223]
    ds_read_b64_tr_b16 v[180:181], v25 offset:12288
    ds_read_b64_tr_b16 v[182:183], v25 offset:14336
    v_cvt_pk_bf16_f32 v125, v6, v7
    v_exp_f32 v4, v94
    v_exp_f32 v5, v95
    v_add_f32 v15, v15, v2
    v_add_f32 v28, v28, v3
    v_mfma_f32_32x32x16_bf16 v[224:239], v[184:187], v[116:119], v[224:239]
    ds_read_b64_tr_b16 v[184:185], v26 offset:12288
    ds_read_b64_tr_b16 v[186:187], v26 offset:14336
    v_cvt_pk_bf16_f32 v126, v2, v3
    v_add_f32 v15, v15, v4
    v_add_f32 v28, v28, v5
    v_cvt_pk_bf16_f32 v127, v4, v5
    v_add_f32 v15, v15, v28
    v_cmp_lt_f32 vcc, s32, v15
    v_mfma_f32_32x32x16_bf16 v[240:255], v[188:191], v[116:119], v[240:255]
    ds_read_b64_tr_b16 v[188:189], v27 offset:12288
    ds_read_b64_tr_b16 v[190:191], v27 offset:14336
    s_cbranch_vccnz F_tr_u15
F_bk_u15:
    v_add_f32 v14, v14, v15
    v_mov_b32 v30, v14
    s_nop 1
    v_permlane32_swap_b32 v14, v30
    v_add_f32 v14, v14, v30
    s_waitcnt lgkmcnt(0)
    v_mfma_f32_32x32x16_bf16 v[192:207], v[160:163], v[120:123], v[192:207]
    v_rcp_f32 v14, v14
    v_lshlrev_b32 v22, 4, v1
    v_add_u32 v16, s19, v22
    v_add_u32 v17, s20, v22
    v_mfma_f32_32x32x16_bf16 v[192:207], v[176:179], v[124:127], v[192:207]
    v_add_u32 v18, s21, v22
    v_add_u32 v19, s22, v22
    v_and_b32 v20, 15, v1
    v_lshrrev_b32 v21, 5, v1
    v_mfma_f32_32x32x16_bf16 v[208:223], v[164:167], v[120:123], v[208:223]
    v_bfe_u32 v23, v1, 4, 1
    v_lshlrev_b32 v20, 4, v20
    v_lshl_add_u32 v20, v21, 8, v20
    v_lshl_add_u32 v21, v23, 10, v20
    v_mfma_f32_32x32x16_bf16 v[208:223], v[180:183], v[124:127], v[208:223]
    v_add_u32 v21, s35, v21
    v_mul_lo_u32 v23, v23, s34
    v_add3_u32 v20, v20, v23, s33
    v_mfma_f32_32x32x16_bf16 v[224:239], v[168:171], v[120:123], v[224:239]
    v_mul_f32 v192, v14, v192
    v_mul_f32 v193, v14, v193
    v_mul_f32 v194, v14, v194
    v_mul_f32 v195, v14, v195
    v_mul_f32 v196, v14, v196
    v_mul_f32 v197, v14, v197
    v_mfma_f32_32x32x16_bf16 v[224:239], v[184:187], v[124:127], v[224:239]
    v_mul_f32 v198, v14, v198
    v_mul_f32 v199, v14, v199
    v_mul_f32 v200, v14, v200
    v_mul_f32 v201, v14, v201
    v_mul_f32 v202, v14, v202
    v_mul_f32 v203, v14, v203
    v_mfma_f32_32x32x16_bf16 v[240:255], v[172:175], v[120:123], v[240:255]
    v_mul_f32 v204, v14, v204
    v_mul_f32 v205, v14, v205
    v_mul_f32 v206, v14, v206
    v_mul_f32 v207, v14, v207
    v_cvt_pk_bf16_f32 v128, v192, v193
    v_cvt_pk_bf16_f32 v129, v194, v195
    v_mfma_f32_32x32x16_bf16 v[240:255], v[188:191], v[124:127], v[240:255]
    v_cvt_pk_bf16_f32 v130, v196, v197
    v_cvt_pk_bf16_f32 v131, v198, v199
    buffer_store_dwordx4 v[128:131], v8, s[24:27], s50 offen sc1
    v_cvt_pk_bf16_f32 v132, v200, v201
    v_cvt_pk_bf16_f32 v133, v202, v203
    v_cvt_pk_bf16_f32 v134, v204, v205
    v_cvt_pk_bf16_f32 v135, v206, v207
    buffer_store_dwordx4 v[132:135], v9, s[24:27], s50 offen sc1
    s_add_u32 s50, s50, 2048
    v_pk_mul_f32 v[208:209], v[208:209], v[14:15] op_sel_hi:[1,0]
    v_pk_mul_f32 v[210:211], v[210:211], v[14:15] op_sel_hi:[1,0]
    v_pk_mul_f32 v[212:213], v[212:213], v[14:15] op_sel_hi:[1,0]
    v_pk_mul_f32 v[214:215], v[214:215], v[14:15] op_sel_hi:[1,0]
    v_pk_mul_f32 v[216:217], v[216:217], v[14:15] op_sel_hi:[1,0]
    v_pk_mul_f32 v[218:219], v[218:219], v[14:15] op_sel_hi:[1,0]
    v_pk_mul_f32 v[220:221], v[220:221], v[14:15] op_sel_hi:[1,0]
    v_pk_mul_f32 v[222:223], v[222:223], v[14:15] op_sel_hi:[1,0]
    v_cvt_pk_bf16_f32 v136, v208, v209
    v_cvt_pk_bf16_f32 v137, v210, v211
    v_cvt_pk_bf16_f32 v138, v212, v213
    v_cvt_pk_bf16_f32 v139, v214, v215
    buffer_store_dwordx4 v[136:139], v8, s[24:27], s50 offen sc1
    v_cvt_pk_bf16_f32 v140, v216, v217
    v_cvt_pk_bf16_f32 v141, v218, v219
    v_cvt_pk_bf16_f32 v142, v220, v221
    v_cvt_pk_bf16_f32 v143, v222, v223
    buffer_store_dwordx4 v[140:143], v9, s[24:27], s50 offen sc1
    s_add_u32 s50, s50, 2048
    s_barrier
    v_pk_mul_f32 v[224:225], v[224:225], v[14:15] op_sel_hi:[1,0]
    v_pk_mul_f32 v[226:227], v[226:227], v[14:15] op_sel_hi:[1,0]
    v_pk_mul_f32 v[228:229], v[228:229], v[14:15] op_sel_hi:[1,0]
    v_pk_mul_f32 v[230:231], v[230:231], v[14:15] op_sel_hi:[1,0]
    v_pk_mul_f32 v[232:233], v[232:233], v[14:15] op_sel_hi:[1,0]
    v_pk_mul_f32 v[234:235], v[234:235], v[14:15] op_sel_hi:[1,0]
    v_pk_mul_f32 v[236:237], v[236:237], v[14:15] op_sel_hi:[1,0]
    v_pk_mul_f32 v[238:239], v[238:239], v[14:15] op_sel_hi:[1,0]
    v_cvt_pk_bf16_f32 v144, v224, v225
    v_cvt_pk_bf16_f32 v145, v226, v227
    v_cvt_pk_bf16_f32 v146, v228, v229
    v_cvt_pk_bf16_f32 v147, v230, v231
    buffer_store_dwordx4 v[144:147], v8, s[24:27], s50 offen sc1
    v_cvt_pk_bf16_f32 v148, v232, v233
    v_cvt_pk_bf16_f32 v149, v234, v235
    v_cvt_pk_bf16_f32 v150, v236, v237
    v_cvt_pk_bf16_f32 v151, v238, v239
    buffer_store_dwordx4 v[148:151], v9, s[24:27], s50 offen sc1
    s_add_u32 s50, s50, 2048
    v_pk_mul_f32 v[240:241], v[240:241], v[14:15] op_sel_hi:[1,0]
    v_pk_mul_f32 v[242:243], v[242:243], v[14:15] op_sel_hi:[1,0]
    v_pk_mul_f32 v[244:245], v[244:245], v[14:15] op_sel_hi:[1,0]
    v_pk_mul_f32 v[246:247], v[246:247], v[14:15] op_sel_hi:[1,0]
    v_pk_mul_f32 v[248:249], v[248:249], v[14:15] op_sel_hi:[1,0]
    v_pk_mul_f32 v[250:251], v[250:251], v[14:15] op_sel_hi:[1,0]
    v_pk_mul_f32 v[252:253], v[252:253], v[14:15] op_sel_hi:[1,0]
    v_pk_mul_f32 v[254:255], v[254:255], v[14:15] op_sel_hi:[1,0]
    v_cvt_pk_bf16_f32 v152, v240, v241
    v_cvt_pk_bf16_f32 v153, v242, v243
    v_cvt_pk_bf16_f32 v154, v244, v245
    v_cvt_pk_bf16_f32 v155, v246, v247
    buffer_store_dwordx4 v[152:155], v8, s[24:27], s50 offen sc1
    v_cvt_pk_bf16_f32 v156, v248, v249
    v_cvt_pk_bf16_f32 v157, v250, v251
    v_cvt_pk_bf16_f32 v158, v252, v253
    v_cvt_pk_bf16_f32 v159, v254, v255
    buffer_store_dwordx4 v[156:159], v9, s[24:27], s50 offen sc1
    s_add_u32 s50, s50, 2048
    ds_write_b128 v20, v[128:131] offset:0
    ds_write_b128 v20, v[132:135] offset:512
    ds_write_b128 v20, v[136:139] offset:5120
    ds_write_b128 v20, v[140:143] offset:5632
    ds_write_b128 v20, v[144:147] offset:10240
    ds_write_b128 v20, v[148:151] offset:10752
    ds_write_b128 v21, v[152:155] offset:0
    ds_write_b128 v21, v[156:159] offset:512
    v_mov_b32 v26, 1
    s_waitcnt lgkmcnt(0)
    s_barrier
    ds_read_b64_tr_b16 v[32:33], v10 offset:0
    ds_read_b64_tr_b16 v[34:35], v10 offset:2048
    ds_read_b128 v[48:51], v16 offset:0
    ds_read_b128 v[52:55], v16 offset:1024
    ds_read_b64_tr_b16 v[36:37], v11 offset:0
    ds_read_b64_tr_b16 v[38:39], v11 offset:2048
    ds_read_b128 v[56:59], v16 offset:2048
    ds_read_b64_tr_b16 v[40:41], v12 offset:0
    ds_read_b64_tr_b16 v[42:43], v12 offset:2048
    ds_read_b128 v[60:63], v16 offset:3072
    ds_read_b64_tr_b16 v[44:45], v13 offset:0
    ds_read_b64_tr_b16 v[46:47], v13 offset:2048
    ds_read_b128 v[64:67], v16 offset:4096
    s_waitcnt lgkmcnt(0)
    v_mfma_f32_16x16x32_bf16 v[104:107], v[32:35], v[48:51], 0
    ds_read_b64_tr_b16 v[68:69], v10 offset:8192
    v_mfma_f32_16x16x32_bf16 v[108:111], v[32:35], v[52:55], 0
    ds_read_b64_tr_b16 v[70:71], v10 offset:10240
    v_mfma_f32_16x16x32_bf16 v[112:115], v[32:35], v[56:59], 0
    ds_read_b128 v[84:87], v16 offset:5120
    v_mfma_f32_16x16x32_bf16 v[116:119], v[32:35], v[60:63], 0
    ds_read_b128 v[88:91], v16 offset:6144
    v_mfma_f32_16x16x32_bf16 v[120:123], v[32:35], v[64:67], 0
    ds_read_b64_tr_b16 v[72:73], v11 offset:8192
    v_mfma_f32_16x16x32_bf16 v[124:127], v[36:39], v[48:51], 0
    ds_read_b64_tr_b16 v[74:75], v11 offset:10240
    v_mfma_f32_16x16x32_bf16 v[128:131], v[36:39], v[52:55], 0
    ds_read_b128 v[92:95], v16 offset:7168
    v_mfma_f32_16x16x32_bf16 v[132:135], v[36:39], v[56:59], 0
    ds_read_b64_tr_b16 v[76:77], v12 offset:8192
    v_mfma_f32_16x16x32_bf16 v[136:139], v[36:39], v[60:63], 0
    ds_read_b64_tr_b16 v[78:79], v12 offset:10240
    v_mfma_f32_16x16x32_bf16 v[140:143], v[36:39], v[64:67], 0
    ds_read_b128 v[96:99], v16 offset:8192
    v_mfma_f32_16x16x32_bf16 v[144:147], v[40:43], v[48:51], 0
    ds_read_b64_tr_b16 v[80:81], v13 offset:8192
    v_mfma_f32_16x16x32_bf16 v[148:151], v[40:43], v[52:55], 0
    ds_read_b64_tr_b16 v[82:83], v13 offset:10240
    v_mfma_f32_16x16x32_bf16 v[152:155], v[40:43], v[56:59], 0
    ds_read_b128 v[100:103], v16 offset:9216
    v_mfma_f32_16x16x32_bf16 v[156:159], v[40:43], v[60:63], 0
    v_mfma_f32_16x16x32_bf16 v[160:163], v[40:43], v[64:67], 0
    v_add_u32 v10, 32768, v10
    v_mfma_f32_16x16x32_bf16 v[164:167], v[44:47], v[48:51], 0
    v_add_u32 v11, 32768, v11
    v_mfma_f32_16x16x32_bf16 v[168:171], v[44:47], v[52:55], 0
    v_add_u32 v12, 32768, v12
    v_mfma_f32_16x16x32_bf16 v[172:175], v[44:47], v[56:59], 0
    v_add_u32 v13, 32768, v13
    v_mfma_f32_16x16x32_bf16 v[176:179], v[44:47], v[60:63], 0
    v_mfma_f32_16x16x32_bf16 v[180:183], v[44:47], v[64:67], 0
    s_mov_b32 s38, 0
F_gloop:
    s_waitcnt vmcnt(0) lgkmcnt(0)
    s_barrier
    s_cmp_lg_u32 s23, 0
    s_cbranch_scc1 F_mf
    s_mov_b32 s23, 1
    s_mov_b64 exec, 1
    buffer_store_dword v26, v1, s[24:27], s48 offen sc1
    s_mov_b64 exec, -1
F_mf:
    v_mfma_f32_16x16x32_bf16 v[104:107], v[68:71], v[84:87], v[104:107]
    ds_read_b64_tr_b16 v[32:33], v10 offset:0
    v_mfma_f32_16x16x32_bf16 v[108:111], v[68:71], v[88:91], v[108:111]
    ds_read_b64_tr_b16 v[34:35], v10 offset:2048
    v_mfma_f32_16x16x32_bf16 v[112:115], v[68:71], v[92:95], v[112:115]
    ds_read_b128 v[48:51], v16 offset:10240
    v_mfma_f32_16x16x32_bf16 v[116:119], v[68:71], v[96:99], v[116:119]
    ds_read_b128 v[52:55], v16 offset:11264
    v_mfma_f32_16x16x32_bf16 v[120:123], v[68:71], v[100:103], v[120:123]
    ds_read_b64_tr_b16 v[36:37], v11 offset:0
    v_mfma_f32_16x16x32_bf16 v[124:127], v[72:75], v[84:87], v[124:127]
    ds_read_b64_tr_b16 v[38:39], v11 offset:2048
    v_mfma_f32_16x16x32_bf16 v[128:131], v[72:75], v[88:91], v[128:131]
    ds_read_b128 v[56:59], v16 offset:12288
    v_mfma_f32_16x16x32_bf16 v[132:135], v[72:75], v[92:95], v[132:135]
    ds_read_b64_tr_b16 v[40:41], v12 offset:0
    v_mfma_f32_16x16x32_bf16 v[136:139], v[72:75], v[96:99], v[136:139]
    ds_read_b64_tr_b16 v[42:43], v12 offset:2048
    v_mfma_f32_16x16x32_bf16 v[140:143], v[72:75], v[100:103], v[140:143]
    ds_read_b128 v[60:63], v16 offset:13312
    v_mfma_f32_16x16x32_bf16 v[144:147], v[76:79], v[84:87], v[144:147]
    ds_read_b64_tr_b16 v[44:45], v13 offset:0
    v_mfma_f32_16x16x32_bf16 v[148:151], v[76:79], v[88:91], v[148:151]
    ds_read_b64_tr_b16 v[46:47], v13 offset:2048
    v_mfma_f32_16x16x32_bf16 v[152:155], v[76:79], v[92:95], v[152:155]
    ds_read_b128 v[64:67], v16 offset:14336
    v_mfma_f32_16x16x32_bf16 v[156:159], v[76:79], v[96:99], v[156:159]
    v_mfma_f32_16x16x32_bf16 v[160:163], v[76:79], v[100:103], v[160:163]
    v_mfma_f32_16x16x32_bf16 v[164:167], v[80:83], v[84:87], v[164:167]
    v_mfma_f32_16x16x32_bf16 v[168:171], v[80:83], v[88:91], v[168:171]
    v_mfma_f32_16x16x32_bf16 v[172:175], v[80:83], v[92:95], v[172:175]
    v_mfma_f32_16x16x32_bf16 v[176:179], v[80:83], v[96:99], v[176:179]
    v_mfma_f32_16x16x32_bf16 v[180:183], v[80:83], v[100:103], v[180:183]
    s_waitcnt lgkmcnt(0)
    v_mfma_f32_16x16x32_bf16 v[104:107], v[32:35], v[48:51], v[104:107]
    ds_read_b64_tr_b16 v[68:69], v10 offset:8192
    v_mfma_f32_16x16x32_bf16 v[108:111], v[32:35], v[52:55], v[108:111]
    ds_read_b64_tr_b16 v[70:71], v10 offset:10240
    v_mfma_f32_16x16x32_bf16 v[112:115], v[32:35], v[56:59], v[112:115]
    ds_read_b128 v[84:87], v17 offset:0
    v_mfma_f32_16x16x32_bf16 v[116:119], v[32:35], v[60:63], v[116:119]
    ds_read_b128 v[88:91], v17 offset:1024
    v_mfma_f32_16x16x32_bf16 v[120:123], v[32:35], v[64:67], v[120:123]
    ds_read_b64_tr_b16 v[72:73], v11 offset:8192
    v_mfma_f32_16x16x32_bf16 v[124:127], v[36:39], v[48:51], v[124:127]
    ds_read_b64_tr_b16 v[74:75], v11 offset:10240
    v_mfma_f32_16x16x32_bf16 v[128:131], v[36:39], v[52:55], v[128:131]
    ds_read_b128 v[92:95], v17 offset:2048
    v_mfma_f32_16x16x32_bf16 v[132:135], v[36:39], v[56:59], v[132:135]
    ds_read_b64_tr_b16 v[76:77], v12 offset:8192
    v_mfma_f32_16x16x32_bf16 v[136:139], v[36:39], v[60:63], v[136:139]
    ds_read_b64_tr_b16 v[78:79], v12 offset:10240
    v_mfma_f32_16x16x32_bf16 v[140:143], v[36:39], v[64:67], v[140:143]
    ds_read_b128 v[96:99], v17 offset:3072
    v_mfma_f32_16x16x32_bf16 v[144:147], v[40:43], v[48:51], v[144:147]
    ds_read_b64_tr_b16 v[80:81], v13 offset:8192
    v_mfma_f32_16x16x32_bf16 v[148:151], v[40:43], v[52:55], v[148:151]
    ds_read_b64_tr_b16 v[82:83], v13 offset:10240
    v_mfma_f32_16x16x32_bf16 v[152:155], v[40:43], v[56:59], v[152:155]
    ds_read_b128 v[100:103], v17 offset:4096
    v_mfma_f32_16x16x32_bf16 v[156:159], v[40:43], v[60:63], v[156:159]
    v_mfma_f32_16x16x32_bf16 v[160:163], v[40:43], v[64:67], v[160:163]
    v_add_u32 v10, 4294950912, v10
    v_mfma_f32_16x16x32_bf16 v[164:167], v[44:47], v[48:51], v[164:167]
    v_add_u32 v11, 4294950912, v11
    v_mfma_f32_16x16x32_bf16 v[168:171], v[44:47], v[52:55], v[168:171]
    v_mfma_f32_16x16x32_bf16 v[172:175], v[44:47], v[56:59], v[172:175]
    v_add_u32 v12, 4294950912, v12
    v_mfma_f32_16x16x32_bf16 v[176:179], v[44:47], v[60:63], v[176:179]
    v_add_u32 v13, 4294950912, v13
    v_mfma_f32_16x16x32_bf16 v[180:183], v[44:47], v[64:67], v[180:183]
    s_waitcnt lgkmcnt(0)
    s_barrier
    v_mfma_f32_16x16x32_bf16 v[104:107], v[68:71], v[84:87], v[104:107]
    ds_read_b64_tr_b16 v[32:33], v10 offset:0
    v_mfma_f32_16x16x32_bf16 v[108:111], v[68:71], v[88:91], v[108:111]
    ds_read_b64_tr_b16 v[34:35], v10 offset:2048
    v_mfma_f32_16x16x32_bf16 v[112:115], v[68:71], v[92:95], v[112:115]
    ds_read_b128 v[48:51], v18 offset:0
    v_mfma_f32_16x16x32_bf16 v[116:119], v[68:71], v[96:99], v[116:119]
    ds_read_b128 v[52:55], v18 offset:1024
    v_mfma_f32_16x16x32_bf16 v[120:123], v[68:71], v[100:103], v[120:123]
    ds_read_b64_tr_b16 v[36:37], v11 offset:0
    v_mfma_f32_16x16x32_bf16 v[124:127], v[72:75], v[84:87], v[124:127]
    ds_read_b64_tr_b16 v[38:39], v11 offset:2048
    v_mfma_f32_16x16x32_bf16 v[128:131], v[72:75], v[88:91], v[128:131]
    ds_read_b128 v[56:59], v18 offset:2048
    v_mfma_f32_16x16x32_bf16 v[132:135], v[72:75], v[92:95], v[132:135]
    ds_read_b64_tr_b16 v[40:41], v12 offset:0
    v_mfma_f32_16x16x32_bf16 v[136:139], v[72:75], v[96:99], v[136:139]
    ds_read_b64_tr_b16 v[42:43], v12 offset:2048
    v_mfma_f32_16x16x32_bf16 v[140:143], v[72:75], v[100:103], v[140:143]
    ds_read_b128 v[60:63], v18 offset:3072
    v_mfma_f32_16x16x32_bf16 v[144:147], v[76:79], v[84:87], v[144:147]
    ds_read_b64_tr_b16 v[44:45], v13 offset:0
    v_mfma_f32_16x16x32_bf16 v[148:151], v[76:79], v[88:91], v[148:151]
    ds_read_b64_tr_b16 v[46:47], v13 offset:2048
    v_mfma_f32_16x16x32_bf16 v[152:155], v[76:79], v[92:95], v[152:155]
    ds_read_b128 v[64:67], v18 offset:4096
    v_mfma_f32_16x16x32_bf16 v[156:159], v[76:79], v[96:99], v[156:159]
    v_mfma_f32_16x16x32_bf16 v[160:163], v[76:79], v[100:103], v[160:163]
    v_mfma_f32_16x16x32_bf16 v[164:167], v[80:83], v[84:87], v[164:167]
    v_mfma_f32_16x16x32_bf16 v[168:171], v[80:83], v[88:91], v[168:171]
    v_mfma_f32_16x16x32_bf16 v[172:175], v[80:83], v[92:95], v[172:175]
    v_mfma_f32_16x16x32_bf16 v[176:179], v[80:83], v[96:99], v[176:179]
    v_mfma_f32_16x16x32_bf16 v[180:183], v[80:83], v[100:103], v[180:183]
    s_waitcnt lgkmcnt(0)
    v_mfma_f32_16x16x32_bf16 v[104:107], v[32:35], v[48:51], v[104:107]
    ds_read_b64_tr_b16 v[68:69], v10 offset:8192
    v_mfma_f32_16x16x32_bf16 v[108:111], v[32:35], v[52:55], v[108:111]
    ds_read_b64_tr_b16 v[70:71], v10 offset:10240
    v_mfma_f32_16x16x32_bf16 v[112:115], v[32:35], v[56:59], v[112:115]
    ds_read_b128 v[84:87], v18 offset:5120
    v_mfma_f32_16x16x32_bf16 v[116:119], v[32:35], v[60:63], v[116:119]
    ds_read_b128 v[88:91], v18 offset:6144
    v_mfma_f32_16x16x32_bf16 v[120:123], v[32:35], v[64:67], v[120:123]
    ds_read_b64_tr_b16 v[72:73], v11 offset:8192
    v_mfma_f32_16x16x32_bf16 v[124:127], v[36:39], v[48:51], v[124:127]
    ds_read_b64_tr_b16 v[74:75], v11 offset:10240
    v_mfma_f32_16x16x32_bf16 v[128:131], v[36:39], v[52:55], v[128:131]
    ds_read_b128 v[92:95], v18 offset:7168
    v_mfma_f32_16x16x32_bf16 v[132:135], v[36:39], v[56:59], v[132:135]
    ds_read_b64_tr_b16 v[76:77], v12 offset:8192
    v_mfma_f32_16x16x32_bf16 v[136:139], v[36:39], v[60:63], v[136:139]
    ds_read_b64_tr_b16 v[78:79], v12 offset:10240
    v_mfma_f32_16x16x32_bf16 v[140:143], v[36:39], v[64:67], v[140:143]
    ds_read_b128 v[96:99], v18 offset:8192
    v_mfma_f32_16x16x32_bf16 v[144:147], v[40:43], v[48:51], v[144:147]
    ds_read_b64_tr_b16 v[80:81], v13 offset:8192
    v_mfma_f32_16x16x32_bf16 v[148:151], v[40:43], v[52:55], v[148:151]
    ds_read_b64_tr_b16 v[82:83], v13 offset:10240
    v_mfma_f32_16x16x32_bf16 v[152:155], v[40:43], v[56:59], v[152:155]
    ds_read_b128 v[100:103], v18 offset:9216
    v_mfma_f32_16x16x32_bf16 v[156:159], v[40:43], v[60:63], v[156:159]
    v_mfma_f32_16x16x32_bf16 v[160:163], v[40:43], v[64:67], v[160:163]
    v_add_u32 v10, 32768, v10
    v_mfma_f32_16x16x32_bf16 v[164:167], v[44:47], v[48:51], v[164:167]
    v_add_u32 v11, 32768, v11
    v_mfma_f32_16x16x32_bf16 v[168:171], v[44:47], v[52:55], v[168:171]
    v_add_u32 v12, 32768, v12
    v_mfma_f32_16x16x32_bf16 v[172:175], v[44:47], v[56:59], v[172:175]
    v_add_u32 v13, 32768, v13
    v_mfma_f32_16x16x32_bf16 v[176:179], v[44:47], v[60:63], v[176:179]
    s_add_u32 s38, s38, 1
    v_mfma_f32_16x16x32_bf16 v[180:183], v[44:47], v[64:67], v[180:183]
    s_cmp_eq_u32 s38, 4
    s_cbranch_scc1 F_gend
    s_waitcnt lgkmcnt(0)
    s_barrier
    v_mfma_f32_16x16x32_bf16 v[104:107], v[68:71], v[84:87], v[104:107]
    ds_read_b64_tr_b16 v[32:33], v10 offset:0
    v_mfma_f32_16x16x32_bf16 v[108:111], v[68:71], v[88:91], v[108:111]
    ds_read_b64_tr_b16 v[34:35], v10 offset:2048
    v_mfma_f32_16x16x32_bf16 v[112:115], v[68:71], v[92:95], v[112:115]
    ds_read_b128 v[48:51], v18 offset:10240
    v_mfma_f32_16x16x32_bf16 v[116:119], v[68:71], v[96:99], v[116:119]
    ds_read_b128 v[52:55], v18 offset:11264
    v_mfma_f32_16x16x32_bf16 v[120:123], v[68:71], v[100:103], v[120:123]
    ds_read_b64_tr_b16 v[36:37], v11 offset:0
    v_mfma_f32_16x16x32_bf16 v[124:127], v[72:75], v[84:87], v[124:127]
    ds_read_b64_tr_b16 v[38:39], v11 offset:2048
    v_mfma_f32_16x16x32_bf16 v[128:131], v[72:75], v[88:91], v[128:131]
    ds_read_b128 v[56:59], v18 offset:12288
    v_mfma_f32_16x16x32_bf16 v[132:135], v[72:75], v[92:95], v[132:135]
    ds_read_b64_tr_b16 v[40:41], v12 offset:0
    v_mfma_f32_16x16x32_bf16 v[136:139], v[72:75], v[96:99], v[136:139]
    ds_read_b64_tr_b16 v[42:43], v12 offset:2048
    v_mfma_f32_16x16x32_bf16 v[140:143], v[72:75], v[100:103], v[140:143]
    ds_read_b128 v[60:63], v18 offset:13312
    v_mfma_f32_16x16x32_bf16 v[144:147], v[76:79], v[84:87], v[144:147]
    ds_read_b64_tr_b16 v[44:45], v13 offset:0
    v_mfma_f32_16x16x32_bf16 v[148:151], v[76:79], v[88:91], v[148:151]
    ds_read_b64_tr_b16 v[46:47], v13 offset:2048
    v_mfma_f32_16x16x32_bf16 v[152:155], v[76:79], v[92:95], v[152:155]
    ds_read_b128 v[64:67], v18 offset:14336
    v_mfma_f32_16x16x32_bf16 v[156:159], v[76:79], v[96:99], v[156:159]
    v_mfma_f32_16x16x32_bf16 v[160:163], v[76:79], v[100:103], v[160:163]
    v_mfma_f32_16x16x32_bf16 v[164:167], v[80:83], v[84:87], v[164:167]
    v_mfma_f32_16x16x32_bf16 v[168:171], v[80:83], v[88:91], v[168:171]
    v_mfma_f32_16x16x32_bf16 v[172:175], v[80:83], v[92:95], v[172:175]
    v_mfma_f32_16x16x32_bf16 v[176:179], v[80:83], v[96:99], v[176:179]
    v_mfma_f32_16x16x32_bf16 v[180:183], v[80:83], v[100:103], v[180:183]
    s_waitcnt lgkmcnt(0)
    v_mfma_f32_16x16x32_bf16 v[104:107], v[32:35], v[48:51], v[104:107]
    ds_read_b64_tr_b16 v[68:69], v10 offset:8192
    v_mfma_f32_16x16x32_bf16 v[108:111], v[32:35], v[52:55], v[108:111]
    ds_read_b64_tr_b16 v[70:71], v10 offset:10240
    v_mfma_f32_16x16x32_bf16 v[112:115], v[32:35], v[56:59], v[112:115]
    ds_read_b128 v[84:87], v19 offset:0
    v_mfma_f32_16x16x32_bf16 v[116:119], v[32:35], v[60:63], v[116:119]
    ds_read_b128 v[88:91], v19 offset:1024
    v_mfma_f32_16x16x32_bf16 v[120:123], v[32:35], v[64:67], v[120:123]
    ds_read_b64_tr_b16 v[72:73], v11 offset:8192
    v_mfma_f32_16x16x32_bf16 v[124:127], v[36:39], v[48:51], v[124:127]
    ds_read_b64_tr_b16 v[74:75], v11 offset:10240
    v_mfma_f32_16x16x32_bf16 v[128:131], v[36:39], v[52:55], v[128:131]
    ds_read_b128 v[92:95], v19 offset:2048
    v_mfma_f32_16x16x32_bf16 v[132:135], v[36:39], v[56:59], v[132:135]
    ds_read_b64_tr_b16 v[76:77], v12 offset:8192
    v_mfma_f32_16x16x32_bf16 v[136:139], v[36:39], v[60:63], v[136:139]
    ds_read_b64_tr_b16 v[78:79], v12 offset:10240
    v_mfma_f32_16x16x32_bf16 v[140:143], v[36:39], v[64:67], v[140:143]
    ds_read_b128 v[96:99], v19 offset:3072
    v_mfma_f32_16x16x32_bf16 v[144:147], v[40:43], v[48:51], v[144:147]
    ds_read_b64_tr_b16 v[80:81], v13 offset:8192
    v_mfma_f32_16x16x32_bf16 v[148:151], v[40:43], v[52:55], v[148:151]
    ds_read_b64_tr_b16 v[82:83], v13 offset:10240
    v_mfma_f32_16x16x32_bf16 v[152:155], v[40:43], v[56:59], v[152:155]
    ds_read_b128 v[100:103], v19 offset:4096
    v_mfma_f32_16x16x32_bf16 v[156:159], v[40:43], v[60:63], v[156:159]
    v_mfma_f32_16x16x32_bf16 v[160:163], v[40:43], v[64:67], v[160:163]
    v_add_u32 v10, 4294918144, v10
    v_mfma_f32_16x16x32_bf16 v[164:167], v[44:47], v[48:51], v[164:167]
    v_add_u32 v11, 4294918144, v11
    v_mfma_f32_16x16x32_bf16 v[168:171], v[44:47], v[52:55], v[168:171]
    v_mfma_f32_16x16x32_bf16 v[172:175], v[44:47], v[56:59], v[172:175]
    v_add_u32 v12, 4294918144, v12
    v_mfma_f32_16x16x32_bf16 v[176:179], v[44:47], v[60:63], v[176:179]
    v_add_u32 v13, 4294918144, v13
    v_mfma_f32_16x16x32_bf16 v[180:183], v[44:47], v[64:67], v[180:183]
    s_waitcnt lgkmcnt(0)
    s_barrier
    v_mfma_f32_16x16x32_bf16 v[104:107], v[68:71], v[84:87], v[104:107]
    ds_read_b64_tr_b16 v[32:33], v10 offset:0
    v_mfma_f32_16x16x32_bf16 v[108:111], v[68:71], v[88:91], v[108:111]
    ds_read_b64_tr_b16 v[34:35], v10 offset:2048
    v_mfma_f32_16x16x32_bf16 v[112:115], v[68:71], v[92:95], v[112:115]
    ds_read_b128 v[48:51], v16 offset:0
    v_mfma_f32_16x16x32_bf16 v[116:119], v[68:71], v[96:99], v[116:119]
    ds_read_b128 v[52:55], v16 offset:1024
    v_mfma_f32_16x16x32_bf16 v[120:123], v[68:71], v[100:103], v[120:123]
    ds_read_b64_tr_b16 v[36:37], v11 offset:0
    v_mfma_f32_16x16x32_bf16 v[124:127], v[72:75], v[84:87], v[124:127]
    ds_read_b64_tr_b16 v[38:39], v11 offset:2048
    v_mfma_f32_16x16x32_bf16 v[128:131], v[72:75], v[88:91], v[128:131]
    ds_read_b128 v[56:59], v16 offset:2048
    v_mfma_f32_16x16x32_bf16 v[132:135], v[72:75], v[92:95], v[132:135]
    ds_read_b64_tr_b16 v[40:41], v12 offset:0
    v_mfma_f32_16x16x32_bf16 v[136:139], v[72:75], v[96:99], v[136:139]
    ds_read_b64_tr_b16 v[42:43], v12 offset:2048
    v_mfma_f32_16x16x32_bf16 v[140:143], v[72:75], v[100:103], v[140:143]
    ds_read_b128 v[60:63], v16 offset:3072
    v_mfma_f32_16x16x32_bf16 v[144:147], v[76:79], v[84:87], v[144:147]
    ds_read_b64_tr_b16 v[44:45], v13 offset:0
    v_mfma_f32_16x16x32_bf16 v[148:151], v[76:79], v[88:91], v[148:151]
    ds_read_b64_tr_b16 v[46:47], v13 offset:2048
    v_mfma_f32_16x16x32_bf16 v[152:155], v[76:79], v[92:95], v[152:155]
    ds_read_b128 v[64:67], v16 offset:4096
    v_mfma_f32_16x16x32_bf16 v[156:159], v[76:79], v[96:99], v[156:159]
    v_mfma_f32_16x16x32_bf16 v[160:163], v[76:79], v[100:103], v[160:163]
    v_mfma_f32_16x16x32_bf16 v[164:167], v[80:83], v[84:87], v[164:167]
    v_mfma_f32_16x16x32_bf16 v[168:171], v[80:83], v[88:91], v[168:171]
    v_mfma_f32_16x16x32_bf16 v[172:175], v[80:83], v[92:95], v[172:175]
    v_mfma_f32_16x16x32_bf16 v[176:179], v[80:83], v[96:99], v[176:179]
    v_mfma_f32_16x16x32_bf16 v[180:183], v[80:83], v[100:103], v[180:183]
    s_waitcnt lgkmcnt(0)
    v_mfma_f32_16x16x32_bf16 v[104:107], v[32:35], v[48:51], v[104:107]
    ds_read_b64_tr_b16 v[68:69], v10 offset:8192
    v_mfma_f32_16x16x32_bf16 v[108:111], v[32:35], v[52:55], v[108:111]
    ds_read_b64_tr_b16 v[70:71], v10 offset:10240
    v_mfma_f32_16x16x32_bf16 v[112:115], v[32:35], v[56:59], v[112:115]
    ds_read_b128 v[84:87], v16 offset:5120
    v_mfma_f32_16x16x32_bf16 v[116:119], v[32:35], v[60:63], v[116:119]
    ds_read_b128 v[88:91], v16 offset:6144
    v_mfma_f32_16x16x32_bf16 v[120:123], v[32:35], v[64:67], v[120:123]
    ds_read_b64_tr_b16 v[72:73], v11 offset:8192
    v_mfma_f32_16x16x32_bf16 v[124:127], v[36:39], v[48:51], v[124:127]
    ds_read_b64_tr_b16 v[74:75], v11 offset:10240
    v_mfma_f32_16x16x32_bf16 v[128:131], v[36:39], v[52:55], v[128:131]
    ds_read_b128 v[92:95], v16 offset:7168
    v_mfma_f32_16x16x32_bf16 v[132:135], v[36:39], v[56:59], v[132:135]
    ds_read_b64_tr_b16 v[76:77], v12 offset:8192
    v_mfma_f32_16x16x32_bf16 v[136:139], v[36:39], v[60:63], v[136:139]
    ds_read_b64_tr_b16 v[78:79], v12 offset:10240
    v_mfma_f32_16x16x32_bf16 v[140:143], v[36:39], v[64:67], v[140:143]
    ds_read_b128 v[96:99], v16 offset:8192
    v_mfma_f32_16x16x32_bf16 v[144:147], v[40:43], v[48:51], v[144:147]
    ds_read_b64_tr_b16 v[80:81], v13 offset:8192
    v_mfma_f32_16x16x32_bf16 v[148:151], v[40:43], v[52:55], v[148:151]
    ds_read_b64_tr_b16 v[82:83], v13 offset:10240
    v_mfma_f32_16x16x32_bf16 v[152:155], v[40:43], v[56:59], v[152:155]
    ds_read_b128 v[100:103], v16 offset:9216
    v_mfma_f32_16x16x32_bf16 v[156:159], v[40:43], v[60:63], v[156:159]
    v_mfma_f32_16x16x32_bf16 v[160:163], v[40:43], v[64:67], v[160:163]
    v_add_u32 v10, 32768, v10
    v_mfma_f32_16x16x32_bf16 v[164:167], v[44:47], v[48:51], v[164:167]
    v_add_u32 v11, 32768, v11
    v_mfma_f32_16x16x32_bf16 v[168:171], v[44:47], v[52:55], v[168:171]
    v_mfma_f32_16x16x32_bf16 v[172:175], v[44:47], v[56:59], v[172:175]
    v_add_u32 v12, 32768, v12
    v_mfma_f32_16x16x32_bf16 v[176:179], v[44:47], v[60:63], v[176:179]
    v_add_u32 v13, 32768, v13
    v_mfma_f32_16x16x32_bf16 v[180:183], v[44:47], v[64:67], v[180:183]
    s_branch F_gloop
F_gend:
    s_waitcnt lgkmcnt(0)
    s_barrier
    v_mfma_f32_16x16x32_bf16 v[104:107], v[68:71], v[84:87], v[104:107]
    ds_read_b64_tr_b16 v[32:33], v10 offset:0
    ds_read_b64_tr_b16 v[34:35], v10 offset:2048
    v_mfma_f32_16x16x32_bf16 v[108:111], v[68:71], v[88:91], v[108:111]
    ds_read_b128 v[48:51], v18 offset:10240
    ds_read_b128 v[52:55], v18 offset:11264
    v_mfma_f32_16x16x32_bf16 v[112:115], v[68:71], v[92:95], v[112:115]
    ds_read_b64_tr_b16 v[36:37], v11 offset:0
    v_mfma_f32_16x16x32_bf16 v[116:119], v[68:71], v[96:99], v[116:119]
    ds_read_b64_tr_b16 v[38:39], v11 offset:2048
    ds_read_b128 v[56:59], v18 offset:12288
    v_mfma_f32_16x16x32_bf16 v[120:123], v[68:71], v[100:103], v[120:123]
    ds_read_b64_tr_b16 v[40:41], v12 offset:0
    ds_read_b64_tr_b16 v[42:43], v12 offset:2048
    v_mfma_f32_16x16x32_bf16 v[124:127], v[72:75], v[84:87], v[124:127]
    ds_read_b128 v[60:63], v18 offset:13312
    v_mfma_f32_16x16x32_bf16 v[128:131], v[72:75], v[88:91], v[128:131]
    ds_read_b64_tr_b16 v[44:45], v13 offset:0
    ds_read_b64_tr_b16 v[46:47], v13 offset:2048
    v_mfma_f32_16x16x32_bf16 v[132:135], v[72:75], v[92:95], v[132:135]
    ds_read_b128 v[64:67], v18 offset:14336
    v_mfma_f32_16x16x32_bf16 v[136:139], v[72:75], v[96:99], v[136:139]
    ds_read_b64_tr_b16 v[192:193], v10 offset:8192
    ds_read_b64_tr_b16 v[194:195], v10 offset:10240
    v_mfma_f32_16x16x32_bf16 v[140:143], v[72:75], v[100:103], v[140:143]
    ds_read_b128 v[208:211], v19 offset:0
    ds_read_b128 v[212:215], v19 offset:1024
    v_mfma_f32_16x16x32_bf16 v[144:147], v[76:79], v[84:87], v[144:147]
    ds_read_b64_tr_b16 v[196:197], v11 offset:8192
    v_mfma_f32_16x16x32_bf16 v[148:151], v[76:79], v[88:91], v[148:151]
    ds_read_b64_tr_b16 v[198:199], v11 offset:10240
    ds_read_b128 v[216:219], v19 offset:2048
    v_mfma_f32_16x16x32_bf16 v[152:155], v[76:79], v[92:95], v[152:155]
    ds_read_b64_tr_b16 v[200:201], v12 offset:8192
    ds_read_b64_tr_b16 v[202:203], v12 offset:10240
    v_mfma_f32_16x16x32_bf16 v[156:159], v[76:79], v[96:99], v[156:159]
    ds_read_b128 v[220:223], v19 offset:3072
    v_mfma_f32_16x16x32_bf16 v[160:163], v[76:79], v[100:103], v[160:163]
    ds_read_b64_tr_b16 v[204:205], v13 offset:8192
    ds_read_b64_tr_b16 v[206:207], v13 offset:10240
    v_mfma_f32_16x16x32_bf16 v[164:167], v[80:83], v[84:87], v[164:167]
    ds_read_b128 v[224:227], v19 offset:4096
    v_mfma_f32_16x16x32_bf16 v[168:171], v[80:83], v[88:91], v[168:171]
    v_mfma_f32_16x16x32_bf16 v[172:175], v[80:83], v[92:95], v[172:175]
    v_mfma_f32_16x16x32_bf16 v[176:179], v[80:83], v[96:99], v[176:179]
    v_mfma_f32_16x16x32_bf16 v[180:183], v[80:83], v[100:103], v[180:183]
    s_waitcnt lgkmcnt(0)
    s_cmp_eq_u32 s55, 0
    s_cbranch_scc0 F_e1
    v_mfma_f32_16x16x32_bf16 v[144:147], v[40:43], v[48:51], v[144:147]
    v_add_u32 v23, 4096, v22
    v_mov_b32 v26, 1
    v_mfma_f32_16x16x32_bf16 v[144:147], v[200:203], v[208:211], v[144:147]
    v_and_b32 v5, 3, v1
    v_mfma_f32_16x16x32_bf16 v[164:167], v[44:47], v[48:51], v[164:167]
    v_max_u32 v239, 1, v5
    v_mfma_f32_16x16x32_bf16 v[164:167], v[204:207], v[208:211], v[164:167]
    v_xor_b32 v239, s54, v239
    v_mfma_f32_16x16x32_bf16 v[148:151], v[40:43], v[52:55], v[148:151]
    v_lshlrev_b32 v239, 9, v239
    v_mfma_f32_16x16x32_bf16 v[148:151], v[200:203], v[212:215], v[148:151]
    v_mfma_f32_16x16x32_bf16 v[168:171], v[44:47], v[52:55], v[168:171]
    v_mfma_f32_16x16x32_bf16 v[168:171], v[204:207], v[212:215], v[168:171]
    v_mfma_f32_16x16x32_bf16 v[152:155], v[40:43], v[56:59], v[152:155]
    v_mfma_f32_16x16x32_bf16 v[152:155], v[200:203], v[216:219], v[152:155]
    v_cvt_pk_bf16_f32 v68, v144, v145
    v_cvt_pk_bf16_f32 v69, v146, v147
    v_mfma_f32_16x16x32_bf16 v[172:175], v[44:47], v[56:59], v[172:175]
    v_mfma_f32_16x16x32_bf16 v[172:175], v[204:207], v[216:219], v[172:175]
    v_cvt_pk_bf16_f32 v70, v164, v165
    v_cvt_pk_bf16_f32 v71, v166, v167
    v_mfma_f32_16x16x32_bf16 v[156:159], v[40:43], v[60:63], v[156:159]
    buffer_store_dwordx4 v[68:71], v22, s[24:27], s17 offen offset:0 sc1
    v_mfma_f32_16x16x32_bf16 v[156:159], v[200:203], v[220:223], v[156:159]
    v_cvt_pk_bf16_f32 v72, v148, v149
    v_cvt_pk_bf16_f32 v73, v150, v151
    v_mfma_f32_16x16x32_bf16 v[176:179], v[44:47], v[60:63], v[176:179]
    v_mfma_f32_16x16x32_bf16 v[176:179], v[204:207], v[220:223], v[176:179]
    v_cvt_pk_bf16_f32 v74, v168, v169
    v_cvt_pk_bf16_f32 v75, v170, v171
    v_mfma_f32_16x16x32_bf16 v[160:163], v[40:43], v[64:67], v[160:163]
    buffer_store_dwordx4 v[72:75], v22, s[24:27], s17 offen offset:1024 sc1
    v_mfma_f32_16x16x32_bf16 v[160:163], v[200:203], v[224:227], v[160:163]
    v_cvt_pk_bf16_f32 v76, v152, v153
    v_cvt_pk_bf16_f32 v77, v154, v155
    v_mfma_f32_16x16x32_bf16 v[180:183], v[44:47], v[64:67], v[180:183]
    v_mfma_f32_16x16x32_bf16 v[180:183], v[204:207], v[224:227], v[180:183]
    v_cvt_pk_bf16_f32 v78, v172, v173
    v_cvt_pk_bf16_f32 v79, v174, v175
    v_mfma_f32_16x16x32_bf16 v[116:119], v[32:35], v[60:63], v[116:119]
    buffer_store_dwordx4 v[76:79], v22, s[24:27], s17 offen offset:2048 sc1
    v_mfma_f32_16x16x32_bf16 v[116:119], v[192:195], v[220:223], v[116:119]
    v_cvt_pk_bf16_f32 v80, v156, v157
    v_cvt_pk_bf16_f32 v81, v158, v159
    v_mfma_f32_16x16x32_bf16 v[136:139], v[36:39], v[60:63], v[136:139]
    v_mfma_f32_16x16x32_bf16 v[136:139], v[196:199], v[220:223], v[136:139]
    v_cvt_pk_bf16_f32 v82, v176, v177
    v_cvt_pk_bf16_f32 v83, v178, v179
    v_mfma_f32_16x16x32_bf16 v[120:123], v[32:35], v[64:67], v[120:123]
    buffer_store_dwordx4 v[80:83], v22, s[24:27], s17 offen offset:3072 sc1
    v_mfma_f32_16x16x32_bf16 v[120:123], v[192:195], v[224:227], v[120:123]
    v_cvt_pk_bf16_f32 v84, v160, v161
    v_cvt_pk_bf16_f32 v85, v162, v163
    v_mfma_f32_16x16x32_bf16 v[140:143], v[36:39], v[64:67], v[140:143]
    v_mfma_f32_16x16x32_bf16 v[140:143], v[196:199], v[224:227], v[140:143]
    v_cvt_pk_bf16_f32 v86, v180, v181
    v_cvt_pk_bf16_f32 v87, v182, v183
    v_mfma_f32_16x16x32_bf16 v[104:107], v[32:35], v[48:51], v[104:107]
    buffer_store_dwordx4 v[84:87], v23, s[24:27], s17 offen offset:0 sc1
    v_mfma_f32_16x16x32_bf16 v[104:107], v[192:195], v[208:211], v[104:107]
    v_cvt_pk_bf16_f32 v88, v116, v117
    v_cvt_pk_bf16_f32 v89, v118, v119
    v_mfma_f32_16x16x32_bf16 v[124:127], v[36:39], v[48:51], v[124:127]
    v_mfma_f32_16x16x32_bf16 v[124:127], v[196:199], v[208:211], v[124:127]
    v_cvt_pk_bf16_f32 v90, v136, v137
    v_cvt_pk_bf16_f32 v91, v138, v139
    v_mfma_f32_16x16x32_bf16 v[108:111], v[32:35], v[52:55], v[108:111]
    buffer_store_dwordx4 v[88:91], v22, s[24:27], s16 offen offset:3072 sc1
    v_mfma_f32_16x16x32_bf16 v[108:111], v[192:195], v[212:215], v[108:111]
    v_cvt_pk_bf16_f32 v92, v120, v121
    v_cvt_pk_bf16_f32 v93, v122, v123
    v_mfma_f32_16x16x32_bf16 v[128:131], v[36:39], v[52:55], v[128:131]
    v_mfma_f32_16x16x32_bf16 v[128:131], v[196:199], v[212:215], v[128:131]
    v_cvt_pk_bf16_f32 v94, v140, v141
    v_cvt_pk_bf16_f32 v95, v142, v143
    v_mfma_f32_16x16x32_bf16 v[112:115], v[32:35], v[56:59], v[112:115]
    buffer_store_dwordx4 v[92:95], v23, s[24:27], s16 offen offset:0 sc1
    v_mfma_f32_16x16x32_bf16 v[112:115], v[192:195], v[216:219], v[112:115]
    v_mfma_f32_16x16x32_bf16 v[132:135], v[36:39], v[56:59], v[132:135]
    v_mfma_f32_16x16x32_bf16 v[132:135], v[196:199], v[216:219], v[132:135]
    v_lshrrev_b32 v2, 4, v1
    v_and_b32 v3, 15, v1
    v_bfe_u32 v4, v1, 2, 2
    v_and_b32 v6, 1, v5
    v_lshlrev_b32 v6, 4, v6
    v_mov_b32 v7, 0x3f80
    v_lshlrev_b32 v6, v6, v7
    v_cmp_eq_u32 vcc, v2, v4
    v_mov_b32 v232, 0
    v_mov_b32 v233, 0
    v_cndmask_b32 v6, 0, v6, vcc
    v_cmp_gt_u32 vcc, 2, v5
    v_mov_b32 v236, 0
    v_mov_b32 v237, 0
    v_cndmask_b32 v234, 0, v6, vcc
    v_sub_u32 v235, v6, v234
    v_and_b32 v6, 1, v2
    v_lshlrev_b32 v238, 11, v3
    v_lshl_add_u32 v238, v6, 5, v238
    v_lshrrev_b32 v6, 1, v2
    v_lshl_add_u32 v238, v6, 4, v238
    s_mov_b32 s38, 0
    s_waitcnt vmcnt(0)
    s_mov_b64 exec, 1
    buffer_store_dword v26, v1, s[24:27], s36 offen sc1
    s_mov_b64 exec, 14
F_poll0:
    buffer_load_dword v24, v239, s[24:27], s15 offen sc1
    s_waitcnt vmcnt(0)
F_pollc0:
    v_cmp_ne_u32 vcc, 1, v24
    s_add_u32 s38, s38, 1
    s_cmp_gt_u32 s38, 2000000
    s_cbranch_scc1 F_polld0
    s_cbranch_vccnz F_poll0
F_polld0:
    s_mov_b64 exec, -1
    buffer_load_dwordx4 v[32:35], v22, s[24:27], s12 offen offset:0 sc1
    buffer_load_dwordx4 v[36:39], v22, s[24:27], s13 offen offset:0 sc1
    buffer_load_dwordx4 v[40:43], v22, s[24:27], s14 offen offset:0 sc1
    buffer_load_dwordx4 v[44:47], v22, s[24:27], s12 offen offset:1024 sc1
    buffer_load_dwordx4 v[48:51], v22, s[24:27], s13 offen offset:1024 sc1
    buffer_load_dwordx4 v[52:55], v22, s[24:27], s14 offen offset:1024 sc1
    buffer_load_dwordx4 v[56:59], v22, s[24:27], s12 offen offset:2048 sc1
    buffer_load_dwordx4 v[60:63], v22, s[24:27], s13 offen offset:2048 sc1
    buffer_load_dwordx4 v[64:67], v22, s[24:27], s14 offen offset:2048 sc1
    s_waitcnt vmcnt(6)
    v_mfma_f32_16x16x32_bf16 v[104:107], v[234:237], v[32:35], v[104:107]
    v_mfma_f32_16x16x32_bf16 v[124:127], v[232:235], v[32:35], v[124:127]
    v_mfma_f32_16x16x32_bf16 v[104:107], v[234:237], v[36:39], v[104:107]
    v_mfma_f32_16x16x32_bf16 v[124:127], v[232:235], v[36:39], v[124:127]
    v_mfma_f32_16x16x32_bf16 v[104:107], v[234:237], v[40:43], v[104:107]
    v_mfma_f32_16x16x32_bf16 v[124:127], v[232:235], v[40:43], v[124:127]
    s_waitcnt vmcnt(3)
    v_mfma_f32_16x16x32_bf16 v[108:111], v[234:237], v[44:47], v[108:111]
    v_mfma_f32_16x16x32_bf16 v[128:131], v[232:235], v[44:47], v[128:131]
    v_mfma_f32_16x16x32_bf16 v[108:111], v[234:237], v[48:51], v[108:111]
    v_mfma_f32_16x16x32_bf16 v[128:131], v[232:235], v[48:51], v[128:131]
    v_mfma_f32_16x16x32_bf16 v[108:111], v[234:237], v[52:55], v[108:111]
    v_mfma_f32_16x16x32_bf16 v[128:131], v[232:235], v[52:55], v[128:131]
    s_waitcnt vmcnt(0)
    v_mfma_f32_16x16x32_bf16 v[112:115], v[234:237], v[56:59], v[112:115]
    v_mfma_f32_16x16x32_bf16 v[132:135], v[232:235], v[56:59], v[132:135]
    v_mfma_f32_16x16x32_bf16 v[112:115], v[234:237], v[60:63], v[112:115]
    v_mfma_f32_16x16x32_bf16 v[132:135], v[232:235], v[60:63], v[132:135]
    v_mfma_f32_16x16x32_bf16 v[112:115], v[234:237], v[64:67], v[112:115]
    v_mfma_f32_16x16x32_bf16 v[132:135], v[232:235], v[64:67], v[132:135]
    s_nop 1
    v_cvt_pk_bf16_f32 v80, v104, v105
    v_cvt_pk_bf16_f32 v81, v106, v107
    v_cvt_pk_bf16_f32 v82, v124, v125
    v_cvt_pk_bf16_f32 v83, v126, v127
    s_nop 1
    v_permlane16_swap_b32 v80, v82
    v_permlane16_swap_b32 v81, v83
    buffer_store_dwordx4 v[80:83], v238, s[8:11], s47 offen
    s_add_u32 s47, s47, 32768
    v_cvt_pk_bf16_f32 v84, v108, v109
    v_cvt_pk_bf16_f32 v85, v110, v111
    v_cvt_pk_bf16_f32 v86, v128, v129
    v_cvt_pk_bf16_f32 v87, v130, v131
    s_nop 1
    v_permlane16_swap_b32 v84, v86
    v_permlane16_swap_b32 v85, v87
    buffer_store_dwordx4 v[84:87], v238, s[8:11], s47 offen
    s_add_u32 s47, s47, 32768
    v_cvt_pk_bf16_f32 v88, v112, v113
    v_cvt_pk_bf16_f32 v89, v114, v115
    v_cvt_pk_bf16_f32 v90, v132, v133
    v_cvt_pk_bf16_f32 v91, v134, v135
    s_nop 1
    v_permlane16_swap_b32 v88, v90
    v_permlane16_swap_b32 v89, v91
    buffer_store_dwordx4 v[88:91], v238, s[8:11], s47 offen
    s_add_u32 s47, s47, 32768
    s_endpgm
F_e1:
    v_mfma_f32_16x16x32_bf16 v[144:147], v[40:43], v[48:51], v[144:147]
    v_add_u32 v23, 4096, v22
    v_mov_b32 v26, 1
    v_mfma_f32_16x16x32_bf16 v[144:147], v[200:203], v[208:211], v[144:147]
    v_and_b32 v5, 3, v1
    v_mfma_f32_16x16x32_bf16 v[164:167], v[44:47], v[48:51], v[164:167]
    v_max_u32 v239, 1, v5
    v_mfma_f32_16x16x32_bf16 v[164:167], v[204:207], v[208:211], v[164:167]
    v_xor_b32 v239, s54, v239
    v_mfma_f32_16x16x32_bf16 v[148:151], v[40:43], v[52:55], v[148:151]
    v_lshlrev_b32 v239, 9, v239
    v_mfma_f32_16x16x32_bf16 v[148:151], v[200:203], v[212:215], v[148:151]
    v_mfma_f32_16x16x32_bf16 v[168:171], v[44:47], v[52:55], v[168:171]
    v_mfma_f32_16x16x32_bf16 v[168:171], v[204:207], v[212:215], v[168:171]
    v_mfma_f32_16x16x32_bf16 v[152:155], v[40:43], v[56:59], v[152:155]
    v_mfma_f32_16x16x32_bf16 v[152:155], v[200:203], v[216:219], v[152:155]
    v_cvt_pk_bf16_f32 v68, v144, v145
    v_cvt_pk_bf16_f32 v69, v146, v147
    v_mfma_f32_16x16x32_bf16 v[172:175], v[44:47], v[56:59], v[172:175]
    v_mfma_f32_16x16x32_bf16 v[172:175], v[204:207], v[216:219], v[172:175]
    v_cvt_pk_bf16_f32 v70, v164, v165
    v_cvt_pk_bf16_f32 v71, v166, v167
    v_mfma_f32_16x16x32_bf16 v[156:159], v[40:43], v[60:63], v[156:159]
    buffer_store_dwordx4 v[68:71], v22, s[24:27], s17 offen offset:0 sc1
    v_mfma_f32_16x16x32_bf16 v[156:159], v[200:203], v[220:223], v[156:159]
    v_cvt_pk_bf16_f32 v72, v148, v149
    v_cvt_pk_bf16_f32 v73, v150, v151
    v_mfma_f32_16x16x32_bf16 v[176:179], v[44:47], v[60:63], v[176:179]
    v_mfma_f32_16x16x32_bf16 v[176:179], v[204:207], v[220:223], v[176:179]
    v_cvt_pk_bf16_f32 v74, v168, v169
    v_cvt_pk_bf16_f32 v75, v170, v171
    v_mfma_f32_16x16x32_bf16 v[160:163], v[40:43], v[64:67], v[160:163]
    buffer_store_dwordx4 v[72:75], v22, s[24:27], s17 offen offset:1024 sc1
    v_mfma_f32_16x16x32_bf16 v[160:163], v[200:203], v[224:227], v[160:163]
    v_cvt_pk_bf16_f32 v76, v152, v153
    v_cvt_pk_bf16_f32 v77, v154, v155
    v_mfma_f32_16x16x32_bf16 v[180:183], v[44:47], v[64:67], v[180:183]
    v_mfma_f32_16x16x32_bf16 v[180:183], v[204:207], v[224:227], v[180:183]
    v_cvt_pk_bf16_f32 v78, v172, v173
    v_cvt_pk_bf16_f32 v79, v174, v175
    v_mfma_f32_16x16x32_bf16 v[104:107], v[32:35], v[48:51], v[104:107]
    buffer_store_dwordx4 v[76:79], v22, s[24:27], s17 offen offset:2048 sc1
    v_mfma_f32_16x16x32_bf16 v[104:107], v[192:195], v[208:211], v[104:107]
    v_cvt_pk_bf16_f32 v80, v156, v157
    v_cvt_pk_bf16_f32 v81, v158, v159
    v_mfma_f32_16x16x32_bf16 v[124:127], v[36:39], v[48:51], v[124:127]
    v_mfma_f32_16x16x32_bf16 v[124:127], v[196:199], v[208:211], v[124:127]
    v_cvt_pk_bf16_f32 v82, v176, v177
    v_cvt_pk_bf16_f32 v83, v178, v179
    v_mfma_f32_16x16x32_bf16 v[108:111], v[32:35], v[52:55], v[108:111]
    buffer_store_dwordx4 v[80:83], v22, s[24:27], s17 offen offset:3072 sc1
    v_mfma_f32_16x16x32_bf16 v[108:111], v[192:195], v[212:215], v[108:111]
    v_cvt_pk_bf16_f32 v84, v160, v161
    v_cvt_pk_bf16_f32 v85, v162, v163
    v_mfma_f32_16x16x32_bf16 v[128:131], v[36:39], v[52:55], v[128:131]
    v_mfma_f32_16x16x32_bf16 v[128:131], v[196:199], v[212:215], v[128:131]
    v_cvt_pk_bf16_f32 v86, v180, v181
    v_cvt_pk_bf16_f32 v87, v182, v183
    v_mfma_f32_16x16x32_bf16 v[112:115], v[32:35], v[56:59], v[112:115]
    buffer_store_dwordx4 v[84:87], v23, s[24:27], s17 offen offset:0 sc1
    v_mfma_f32_16x16x32_bf16 v[112:115], v[192:195], v[216:219], v[112:115]
    v_cvt_pk_bf16_f32 v88, v104, v105
    v_cvt_pk_bf16_f32 v89, v106, v107
    v_mfma_f32_16x16x32_bf16 v[132:135], v[36:39], v[56:59], v[132:135]
    v_mfma_f32_16x16x32_bf16 v[132:135], v[196:199], v[216:219], v[132:135]
    v_cvt_pk_bf16_f32 v90, v124, v125
    v_cvt_pk_bf16_f32 v91, v126, v127
    v_mfma_f32_16x16x32_bf16 v[116:119], v[32:35], v[60:63], v[116:119]
    buffer_store_dwordx4 v[88:91], v22, s[24:27], s16 offen offset:0 sc1
    v_mfma_f32_16x16x32_bf16 v[116:119], v[192:195], v[220:223], v[116:119]
    v_cvt_pk_bf16_f32 v92, v108, v109
    v_cvt_pk_bf16_f32 v93, v110, v111
    v_mfma_f32_16x16x32_bf16 v[136:139], v[36:39], v[60:63], v[136:139]
    v_mfma_f32_16x16x32_bf16 v[136:139], v[196:199], v[220:223], v[136:139]
    v_cvt_pk_bf16_f32 v94, v128, v129
    v_cvt_pk_bf16_f32 v95, v130, v131
    v_mfma_f32_16x16x32_bf16 v[120:123], v[32:35], v[64:67], v[120:123]
    buffer_store_dwordx4 v[92:95], v22, s[24:27], s16 offen offset:1024 sc1
    v_mfma_f32_16x16x32_bf16 v[120:123], v[192:195], v[224:227], v[120:123]
    v_cvt_pk_bf16_f32 v96, v112, v113
    v_cvt_pk_bf16_f32 v97, v114, v115
    v_mfma_f32_16x16x32_bf16 v[140:143], v[36:39], v[64:67], v[140:143]
    v_mfma_f32_16x16x32_bf16 v[140:143], v[196:199], v[224:227], v[140:143]
    v_cvt_pk_bf16_f32 v98, v132, v133
    v_cvt_pk_bf16_f32 v99, v134, v135
    buffer_store_dwordx4 v[96:99], v22, s[24:27], s16 offen offset:2048 sc1
    v_lshrrev_b32 v2, 4, v1
    v_and_b32 v3, 15, v1
    v_bfe_u32 v4, v1, 2, 2
    v_and_b32 v6, 1, v5
    v_lshlrev_b32 v6, 4, v6
    v_mov_b32 v7, 0x3f80
    v_lshlrev_b32 v6, v6, v7
    v_cmp_eq_u32 vcc, v2, v4
    v_mov_b32 v232, 0
    v_mov_b32 v233, 0
    v_cndmask_b32 v6, 0, v6, vcc
    v_cmp_gt_u32 vcc, 2, v5
    v_mov_b32 v236, 0
    v_mov_b32 v237, 0
    v_cndmask_b32 v234, 0, v6, vcc
    v_sub_u32 v235, v6, v234
    v_and_b32 v6, 1, v2
    v_lshlrev_b32 v238, 11, v3
    v_lshl_add_u32 v238, v6, 5, v238
    v_lshrrev_b32 v6, 1, v2
    v_lshl_add_u32 v238, v6, 4, v238
    s_mov_b32 s38, 0
    s_waitcnt vmcnt(0)
    s_mov_b64 exec, 1
    buffer_store_dword v26, v1, s[24:27], s36 offen sc1
    s_mov_b64 exec, 14
F_poll1:
    buffer_load_dword v24, v239, s[24:27], s15 offen sc1
    s_waitcnt vmcnt(0)
F_pollc1:
    v_cmp_ne_u32 vcc, 1, v24
    s_add_u32 s38, s38, 1
    s_cmp_gt_u32 s38, 2000000
    s_cbranch_scc1 F_polld1
    s_cbranch_vccnz F_poll1
F_polld1:
    s_mov_b64 exec, -1
    buffer_load_dwordx4 v[32:35], v22, s[24:27], s12 offen offset:3072 sc1
    buffer_load_dwordx4 v[36:39], v22, s[24:27], s13 offen offset:3072 sc1
    buffer_load_dwordx4 v[40:43], v22, s[24:27], s14 offen offset:3072 sc1
    buffer_load_dwordx4 v[44:47], v23, s[24:27], s12 offen offset:0 sc1
    buffer_load_dwordx4 v[48:51], v23, s[24:27], s13 offen offset:0 sc1
    buffer_load_dwordx4 v[52:55], v23, s[24:27], s14 offen offset:0 sc1
    s_add_u32 s47, s47, 98304
    s_waitcnt vmcnt(3)
    v_mfma_f32_16x16x32_bf16 v[116:119], v[234:237], v[32:35], v[116:119]
    v_mfma_f32_16x16x32_bf16 v[136:139], v[232:235], v[32:35], v[136:139]
    v_mfma_f32_16x16x32_bf16 v[116:119], v[234:237], v[36:39], v[116:119]
    v_mfma_f32_16x16x32_bf16 v[136:139], v[232:235], v[36:39], v[136:139]
    v_mfma_f32_16x16x32_bf16 v[116:119], v[234:237], v[40:43], v[116:119]
    v_mfma_f32_16x16x32_bf16 v[136:139], v[232:235], v[40:43], v[136:139]
    s_waitcnt vmcnt(0)
    v_mfma_f32_16x16x32_bf16 v[120:123], v[234:237], v[44:47], v[120:123]
    v_mfma_f32_16x16x32_bf16 v[140:143], v[232:235], v[44:47], v[140:143]
    v_mfma_f32_16x16x32_bf16 v[120:123], v[234:237], v[48:51], v[120:123]
    v_mfma_f32_16x16x32_bf16 v[140:143], v[232:235], v[48:51], v[140:143]
    v_mfma_f32_16x16x32_bf16 v[120:123], v[234:237], v[52:55], v[120:123]
    v_mfma_f32_16x16x32_bf16 v[140:143], v[232:235], v[52:55], v[140:143]
    s_nop 1
    v_cvt_pk_bf16_f32 v80, v116, v117
    v_cvt_pk_bf16_f32 v81, v118, v119
    v_cvt_pk_bf16_f32 v82, v136, v137
    v_cvt_pk_bf16_f32 v83, v138, v139
    s_nop 1
    v_permlane16_swap_b32 v80, v82
    v_permlane16_swap_b32 v81, v83
    buffer_store_dwordx4 v[80:83], v238, s[8:11], s47 offen
    s_add_u32 s47, s47, 32768
    s_nop 1
    v_cvt_pk_bf16_f32 v84, v120, v121
    v_cvt_pk_bf16_f32 v85, v122, v123
    v_cvt_pk_bf16_f32 v86, v140, v141
    v_cvt_pk_bf16_f32 v87, v142, v143
    s_nop 1
    v_permlane16_swap_b32 v84, v86
    v_permlane16_swap_b32 v85, v87
    buffer_store_dwordx4 v[84:87], v238, s[8:11], s47 offen
    s_add_u32 s47, s47, 32768
    s_endpgm
F_cnt:
    s_mov_b32 s38, 0
    v_mov_b32 v6, 0
F_cnt1:
    buffer_load_dword v121, v6, s[60:63], 0 offen sc1
    s_waitcnt vmcnt(0)
    v_cmp_gt_u32 vcc, 0x100, v121
    s_add_u32 s38, s38, 1
    s_cmp_gt_u32 s38, 2000000
    s_cbranch_scc1 F_cntd
    s_cbranch_vccnz F_cnt1
    s_branch F_cntd
F_tr_u0:
    s_call_b64 s[40:41], F_raref
    s_branch F_bk_u0
F_tr_u1:
    s_call_b64 s[40:41], F_rare1
    s_branch F_bk_u1
F_tr_u2:
    s_call_b64 s[40:41], F_rare0
    s_branch F_bk_u2
F_tr_u3:
    s_call_b64 s[40:41], F_rare1
    s_branch F_bk_u3
F_tr_u4:
    s_call_b64 s[40:41], F_rare0
    s_branch F_bk_u4
F_tr_u5:
    s_call_b64 s[40:41], F_rare1
    s_branch F_bk_u5
F_tr_u6:
    s_call_b64 s[40:41], F_rare0
    s_branch F_bk_u6
F_tr_u7:
    s_call_b64 s[40:41], F_rare1
    s_branch F_bk_u7
F_tr_u8:
    s_call_b64 s[40:41], F_rare0
    s_branch F_bk_u8
F_tr_u9:
    s_call_b64 s[40:41], F_rare1
    s_branch F_bk_u9
F_tr_u10:
    s_call_b64 s[40:41], F_rare0
    s_branch F_bk_u10
F_tr_u11:
    s_call_b64 s[40:41], F_rare1
    s_branch F_bk_u11
F_tr_u12:
    s_call_b64 s[40:41], F_rare0
    s_branch F_bk_u12
F_tr_u13:
    s_call_b64 s[40:41], F_rare1
    s_branch F_bk_u13
F_tr_u14:
    s_call_b64 s[40:41], F_rare0
    s_branch F_bk_u14
F_tr_u15:
    s_call_b64 s[40:41], F_rare1
    s_branch F_bk_u15
F_tr_h0:
    s_call_b64 s[40:41], F_rarehf
    s_branch F_bk_h0
F_tr_h1:
    s_call_b64 s[40:41], F_rareh
    s_branch F_bk_h1
F_tr_h2:
    s_call_b64 s[40:41], F_rareh
    s_branch F_bk_h2
F_tr_h3:
    s_call_b64 s[40:41], F_rareh
    s_branch F_bk_h3
F_rare0:
    s_nop 15
    v_max3_f32 v28, v64, v65, v66
    v_max3_f32 v29, v67, v68, v69
    v_max3_f32 v28, v28, v70, v71
    v_max3_f32 v29, v29, v72, v73
    v_max3_f32 v28, v28, v74, v75
    v_max3_f32 v29, v29, v76, v77
    v_max3_f32 v28, v28, v78, v79
    v_max_f32 v28, v28, v29
    v_mov_b32 v30, v28
    s_nop 1
    v_permlane32_swap_b32 v28, v30
    v_max_f32 v28, v28, v30
    v_max_f32 v28, 0, v28
    v_ceil_f32 v28, v28
    v_sub_f32 v29, 0, v28
    v_exp_f32 v29, v29
    v_sub_f32 v64, v64, v28
    v_sub_f32 v80, v80, v28
    v_sub_f32 v96, v96, v28
    v_sub_f32 v65, v65, v28
    v_sub_f32 v81, v81, v28
    v_sub_f32 v97, v97, v28
    v_sub_f32 v66, v66, v28
    v_sub_f32 v82, v82, v28
    v_sub_f32 v98, v98, v28
    v_sub_f32 v67, v67, v28
    v_sub_f32 v83, v83, v28
    v_sub_f32 v99, v99, v28
    v_sub_f32 v68, v68, v28
    v_sub_f32 v84, v84, v28
    v_sub_f32 v100, v100, v28
    v_sub_f32 v69, v69, v28
    v_sub_f32 v85, v85, v28
    v_sub_f32 v101, v101, v28
    v_sub_f32 v70, v70, v28
    v_sub_f32 v86, v86, v28
    v_sub_f32 v102, v102, v28
    v_sub_f32 v71, v71, v28
    v_sub_f32 v87, v87, v28
    v_sub_f32 v103, v103, v28
    v_sub_f32 v72, v72, v28
    v_sub_f32 v88, v88, v28
    v_sub_f32 v104, v104, v28
    v_sub_f32 v73, v73, v28
    v_sub_f32 v89, v89, v28
    v_sub_f32 v105, v105, v28
    v_sub_f32 v74, v74, v28
    v_sub_f32 v90, v90, v28
    v_sub_f32 v106, v106, v28
    v_sub_f32 v75, v75, v28
    v_sub_f32 v91, v91, v28
    v_sub_f32 v107, v107, v28
    v_sub_f32 v76, v76, v28
    v_sub_f32 v92, v92, v28
    v_sub_f32 v108, v108, v28
    v_sub_f32 v77, v77, v28
    v_sub_f32 v93, v93, v28
    v_sub_f32 v109, v109, v28
    v_sub_f32 v78, v78, v28
    v_sub_f32 v94, v94, v28
    v_sub_f32 v110, v110, v28
    v_sub_f32 v79, v79, v28
    v_sub_f32 v95, v95, v28
    v_sub_f32 v111, v111, v28
    v_mul_f32 v192, v29, v192
    v_mul_f32 v193, v29, v193
    v_mul_f32 v194, v29, v194
    v_mul_f32 v195, v29, v195
    v_mul_f32 v196, v29, v196
    v_mul_f32 v197, v29, v197
    v_mul_f32 v198, v29, v198
    v_mul_f32 v199, v29, v199
    v_mul_f32 v200, v29, v200
    v_mul_f32 v201, v29, v201
    v_mul_f32 v202, v29, v202
    v_mul_f32 v203, v29, v203
    v_mul_f32 v204, v29, v204
    v_mul_f32 v205, v29, v205
    v_mul_f32 v206, v29, v206
    v_mul_f32 v207, v29, v207
    v_mul_f32 v208, v29, v208
    v_mul_f32 v209, v29, v209
    v_mul_f32 v210, v29, v210
    v_mul_f32 v211, v29, v211
    v_mul_f32 v212, v29, v212
    v_mul_f32 v213, v29, v213
    v_mul_f32 v214, v29, v214
    v_mul_f32 v215, v29, v215
    v_mul_f32 v216, v29, v216
    v_mul_f32 v217, v29, v217
    v_mul_f32 v218, v29, v218
    v_mul_f32 v219, v29, v219
    v_mul_f32 v220, v29, v220
    v_mul_f32 v221, v29, v221
    v_mul_f32 v222, v29, v222
    v_mul_f32 v223, v29, v223
    v_mul_f32 v224, v29, v224
    v_mul_f32 v225, v29, v225
    v_mul_f32 v226, v29, v226
    v_mul_f32 v227, v29, v227
    v_mul_f32 v228, v29, v228
    v_mul_f32 v229, v29, v229
    v_mul_f32 v230, v29, v230
    v_mul_f32 v231, v29, v231
    v_mul_f32 v232, v29, v232
    v_mul_f32 v233, v29, v233
    v_mul_f32 v234, v29, v234
    v_mul_f32 v235, v29, v235
    v_mul_f32 v236, v29, v236
    v_mul_f32 v237, v29, v237
    v_mul_f32 v238, v29, v238
    v_mul_f32 v239, v29, v239
    v_mul_f32 v240, v29, v240
    v_mul_f32 v241, v29, v241
    v_mul_f32 v242, v29, v242
    v_mul_f32 v243, v29, v243
    v_mul_f32 v244, v29, v244
    v_mul_f32 v245, v29, v245
    v_mul_f32 v246, v29, v246
    v_mul_f32 v247, v29, v247
    v_mul_f32 v248, v29, v248
    v_mul_f32 v249, v29, v249
    v_mul_f32 v250, v29, v250
    v_mul_f32 v251, v29, v251
    v_mul_f32 v252, v29, v252
    v_mul_f32 v253, v29, v253
    v_mul_f32 v254, v29, v254
    v_mul_f32 v255, v29, v255
    v_mul_f32 v14, v29, v14
    v_exp_f32 v2, v64
    v_exp_f32 v3, v65
    v_exp_f32 v4, v66
    v_exp_f32 v5, v67
    v_add_f32 v15, v2, v3
    v_cvt_pk_bf16_f32 v112, v2, v3
    v_exp_f32 v6, v68
    v_exp_f32 v7, v69
    v_add_f32 v28, v4, v5
    v_cvt_pk_bf16_f32 v113, v4, v5
    v_exp_f32 v2, v70
    v_exp_f32 v3, v71
    v_add_f32 v15, v15, v6
    v_add_f32 v28, v28, v7
    v_cvt_pk_bf16_f32 v114, v6, v7
    v_exp_f32 v4, v72
    v_exp_f32 v5, v73
    v_add_f32 v15, v15, v2
    v_add_f32 v28, v28, v3
    v_cvt_pk_bf16_f32 v115, v2, v3
    v_exp_f32 v6, v74
    v_exp_f32 v7, v75
    v_add_f32 v15, v15, v4
    v_add_f32 v28, v28, v5
    v_cvt_pk_bf16_f32 v116, v4, v5
    v_exp_f32 v2, v76
    v_exp_f32 v3, v77
    v_add_f32 v15, v15, v6
    v_add_f32 v28, v28, v7
    v_cvt_pk_bf16_f32 v117, v6, v7
    v_exp_f32 v4, v78
    v_exp_f32 v5, v79
    v_add_f32 v15, v15, v2
    v_add_f32 v28, v28, v3
    v_cvt_pk_bf16_f32 v118, v2, v3
    v_add_f32 v15, v15, v4
    v_add_f32 v28, v28, v5
    v_cvt_pk_bf16_f32 v119, v4, v5
    v_add_f32 v15, v15, v28
    s_nop 1
    s_setpc_b64 s[40:41]
F_rare1:
    s_nop 15
    v_max3_f32 v28, v80, v81, v82
    v_max3_f32 v29, v83, v84, v85
    v_max3_f32 v28, v28, v86, v87
    v_max3_f32 v29, v29, v88, v89
    v_max3_f32 v28, v28, v90, v91
    v_max3_f32 v29, v29, v92, v93
    v_max3_f32 v28, v28, v94, v95
    v_max_f32 v28, v28, v29
    v_mov_b32 v30, v28
    s_nop 1
    v_permlane32_swap_b32 v28, v30
    v_max_f32 v28, v28, v30
    v_max_f32 v28, 0, v28
    v_ceil_f32 v28, v28
    v_sub_f32 v29, 0, v28
    v_exp_f32 v29, v29
    v_sub_f32 v64, v64, v28
    v_sub_f32 v80, v80, v28
    v_sub_f32 v96, v96, v28
    v_sub_f32 v65, v65, v28
    v_sub_f32 v81, v81, v28
    v_sub_f32 v97, v97, v28
    v_sub_f32 v66, v66, v28
    v_sub_f32 v82, v82, v28
    v_sub_f32 v98, v98, v28
    v_sub_f32 v67, v67, v28
    v_sub_f32 v83, v83, v28
    v_sub_f32 v99, v99, v28
    v_sub_f32 v68, v68, v28
    v_sub_f32 v84, v84, v28
    v_sub_f32 v100, v100, v28
    v_sub_f32 v69, v69, v28
    v_sub_f32 v85, v85, v28
    v_sub_f32 v101, v101, v28
    v_sub_f32 v70, v70, v28
    v_sub_f32 v86, v86, v28
    v_sub_f32 v102, v102, v28
    v_sub_f32 v71, v71, v28
    v_sub_f32 v87, v87, v28
    v_sub_f32 v103, v103, v28
    v_sub_f32 v72, v72, v28
    v_sub_f32 v88, v88, v28
    v_sub_f32 v104, v104, v28
    v_sub_f32 v73, v73, v28
    v_sub_f32 v89, v89, v28
    v_sub_f32 v105, v105, v28
    v_sub_f32 v74, v74, v28
    v_sub_f32 v90, v90, v28
    v_sub_f32 v106, v106, v28
    v_sub_f32 v75, v75, v28
    v_sub_f32 v91, v91, v28
    v_sub_f32 v107, v107, v28
    v_sub_f32 v76, v76, v28
    v_sub_f32 v92, v92, v28
    v_sub_f32 v108, v108, v28
    v_sub_f32 v77, v77, v28
    v_sub_f32 v93, v93, v28
    v_sub_f32 v109, v109, v28
    v_sub_f32 v78, v78, v28
    v_sub_f32 v94, v94, v28
    v_sub_f32 v110, v110, v28
    v_sub_f32 v79, v79, v28
    v_sub_f32 v95, v95, v28
    v_sub_f32 v111, v111, v28
    v_mul_f32 v192, v29, v192
    v_mul_f32 v193, v29, v193
    v_mul_f32 v194, v29, v194
    v_mul_f32 v195, v29, v195
    v_mul_f32 v196, v29, v196
    v_mul_f32 v197, v29, v197
    v_mul_f32 v198, v29, v198
    v_mul_f32 v199, v29, v199
    v_mul_f32 v200, v29, v200
    v_mul_f32 v201, v29, v201
    v_mul_f32 v202, v29, v202
    v_mul_f32 v203, v29, v203
    v_mul_f32 v204, v29, v204
    v_mul_f32 v205, v29, v205
    v_mul_f32 v206, v29, v206
    v_mul_f32 v207, v29, v207
    v_mul_f32 v208, v29, v208
    v_mul_f32 v209, v29, v209
    v_mul_f32 v210, v29, v210
    v_mul_f32 v211, v29, v211
    v_mul_f32 v212, v29, v212
    v_mul_f32 v213, v29, v213
    v_mul_f32 v214, v29, v214
    v_mul_f32 v215, v29, v215
    v_mul_f32 v216, v29, v216
    v_mul_f32 v217, v29, v217
    v_mul_f32 v218, v29, v218
    v_mul_f32 v219, v29, v219
    v_mul_f32 v220, v29, v220
    v_mul_f32 v221, v29, v221
    v_mul_f32 v222, v29, v222
    v_mul_f32 v223, v29, v223
    v_mul_f32 v224, v29, v224
    v_mul_f32 v225, v29, v225
    v_mul_f32 v226, v29, v226
    v_mul_f32 v227, v29, v227
    v_mul_f32 v228, v29, v228
    v_mul_f32 v229, v29, v229
    v_mul_f32 v230, v29, v230
    v_mul_f32 v231, v29, v231
    v_mul_f32 v232, v29, v232
    v_mul_f32 v233, v29, v233
    v_mul_f32 v234, v29, v234
    v_mul_f32 v235, v29, v235
    v_mul_f32 v236, v29, v236
    v_mul_f32 v237, v29, v237
    v_mul_f32 v238, v29, v238
    v_mul_f32 v239, v29, v239
    v_mul_f32 v240, v29, v240
    v_mul_f32 v241, v29, v241
    v_mul_f32 v242, v29, v242
    v_mul_f32 v243, v29, v243
    v_mul_f32 v244, v29, v244
    v_mul_f32 v245, v29, v245
    v_mul_f32 v246, v29, v246
    v_mul_f32 v247, v29, v247
    v_mul_f32 v248, v29, v248
    v_mul_f32 v249, v29, v249
    v_mul_f32 v250, v29, v250
    v_mul_f32 v251, v29, v251
    v_mul_f32 v252, v29, v252
    v_mul_f32 v253, v29, v253
    v_mul_f32 v254, v29, v254
    v_mul_f32 v255, v29, v255
    v_mul_f32 v14, v29, v14
    v_exp_f32 v2, v80
    v_exp_f32 v3, v81
    v_exp_f32 v4, v82
    v_exp_f32 v5, v83
    v_add_f32 v15, v2, v3
    v_cvt_pk_bf16_f32 v120, v2, v3
    v_exp_f32 v6, v84
    v_exp_f32 v7, v85
    v_add_f32 v28, v4, v5
    v_cvt_pk_bf16_f32 v121, v4, v5
    v_exp_f32 v2, v86
    v_exp_f32 v3, v87
    v_add_f32 v15, v15, v6
    v_add_f32 v28, v28, v7
    v_cvt_pk_bf16_f32 v122, v6, v7
    v_exp_f32 v4, v88
    v_exp_f32 v5, v89
    v_add_f32 v15, v15, v2
    v_add_f32 v28, v28, v3
    v_cvt_pk_bf16_f32 v123, v2, v3
    v_exp_f32 v6, v90
    v_exp_f32 v7, v91
    v_add_f32 v15, v15, v4
    v_add_f32 v28, v28, v5
    v_cvt_pk_bf16_f32 v124, v4, v5
    v_exp_f32 v2, v92
    v_exp_f32 v3, v93
    v_add_f32 v15, v15, v6
    v_add_f32 v28, v28, v7
    v_cvt_pk_bf16_f32 v125, v6, v7
    v_exp_f32 v4, v94
    v_exp_f32 v5, v95
    v_add_f32 v15, v15, v2
    v_add_f32 v28, v28, v3
    v_cvt_pk_bf16_f32 v126, v2, v3
    v_add_f32 v15, v15, v4
    v_add_f32 v28, v28, v5
    v_cvt_pk_bf16_f32 v127, v4, v5
    v_add_f32 v15, v15, v28
    s_nop 1
    s_setpc_b64 s[40:41]
F_raref:
    s_nop 15
    v_max3_f32 v28, v64, v65, v66
    v_max3_f32 v29, v67, v68, v69
    v_max3_f32 v28, v28, v70, v71
    v_max3_f32 v29, v29, v72, v73
    v_max3_f32 v28, v28, v74, v75
    v_max3_f32 v29, v29, v76, v77
    v_max3_f32 v28, v28, v78, v79
    v_max_f32 v28, v28, v29
    v_mov_b32 v30, v28
    s_nop 1
    v_permlane32_swap_b32 v28, v30
    v_max_f32 v28, v28, v30
    v_ceil_f32 v28, v28
    v_sub_f32 v64, v64, v28
    v_sub_f32 v80, v80, v28
    v_sub_f32 v96, v96, v28
    v_sub_f32 v65, v65, v28
    v_sub_f32 v81, v81, v28
    v_sub_f32 v97, v97, v28
    v_sub_f32 v66, v66, v28
    v_sub_f32 v82, v82, v28
    v_sub_f32 v98, v98, v28
    v_sub_f32 v67, v67, v28
    v_sub_f32 v83, v83, v28
    v_sub_f32 v99, v99, v28
    v_sub_f32 v68, v68, v28
    v_sub_f32 v84, v84, v28
    v_sub_f32 v100, v100, v28
    v_sub_f32 v69, v69, v28
    v_sub_f32 v85, v85, v28
    v_sub_f32 v101, v101, v28
    v_sub_f32 v70, v70, v28
    v_sub_f32 v86, v86, v28
    v_sub_f32 v102, v102, v28
    v_sub_f32 v71, v71, v28
    v_sub_f32 v87, v87, v28
    v_sub_f32 v103, v103, v28
    v_sub_f32 v72, v72, v28
    v_sub_f32 v88, v88, v28
    v_sub_f32 v104, v104, v28
    v_sub_f32 v73, v73, v28
    v_sub_f32 v89, v89, v28
    v_sub_f32 v105, v105, v28
    v_sub_f32 v74, v74, v28
    v_sub_f32 v90, v90, v28
    v_sub_f32 v106, v106, v28
    v_sub_f32 v75, v75, v28
    v_sub_f32 v91, v91, v28
    v_sub_f32 v107, v107, v28
    v_sub_f32 v76, v76, v28
    v_sub_f32 v92, v92, v28
    v_sub_f32 v108, v108, v28
    v_sub_f32 v77, v77, v28
    v_sub_f32 v93, v93, v28
    v_sub_f32 v109, v109, v28
    v_sub_f32 v78, v78, v28
    v_sub_f32 v94, v94, v28
    v_sub_f32 v110, v110, v28
    v_sub_f32 v79, v79, v28
    v_sub_f32 v95, v95, v28
    v_sub_f32 v111, v111, v28
    v_exp_f32 v2, v64
    v_exp_f32 v3, v65
    v_exp_f32 v4, v66
    v_exp_f32 v5, v67
    v_add_f32 v15, v2, v3
    v_cvt_pk_bf16_f32 v112, v2, v3
    v_exp_f32 v6, v68
    v_exp_f32 v7, v69
    v_add_f32 v28, v4, v5
    v_cvt_pk_bf16_f32 v113, v4, v5
    v_exp_f32 v2, v70
    v_exp_f32 v3, v71
    v_add_f32 v15, v15, v6
    v_add_f32 v28, v28, v7
    v_cvt_pk_bf16_f32 v114, v6, v7
    v_exp_f32 v4, v72
    v_exp_f32 v5, v73
    v_add_f32 v15, v15, v2
    v_add_f32 v28, v28, v3
    v_cvt_pk_bf16_f32 v115, v2, v3
    v_exp_f32 v6, v74
    v_exp_f32 v7, v75
    v_add_f32 v15, v15, v4
    v_add_f32 v28, v28, v5
    v_cvt_pk_bf16_f32 v116, v4, v5
    v_exp_f32 v2, v76
    v_exp_f32 v3, v77
    v_add_f32 v15, v15, v6
    v_add_f32 v28, v28, v7
    v_cvt_pk_bf16_f32 v117, v6, v7
    v_exp_f32 v4, v78
    v_exp_f32 v5, v79
    v_add_f32 v15, v15, v2
    v_add_f32 v28, v28, v3
    v_cvt_pk_bf16_f32 v118, v2, v3
    v_add_f32 v15, v15, v4
    v_add_f32 v28, v28, v5
    v_cvt_pk_bf16_f32 v119, v4, v5
    v_add_f32 v15, v15, v28
    s_nop 1
    s_setpc_b64 s[40:41]
F_rareh:
    s_nop 15
    v_max3_f32 v28, v64, v65, v66
    v_max3_f32 v29, v67, v68, v69
    v_max3_f32 v28, v28, v70, v71
    v_max3_f32 v29, v29, v72, v73
    v_max3_f32 v28, v28, v74, v75
    v_max3_f32 v29, v29, v76, v77
    v_max3_f32 v28, v28, v78, v79
    v_max_f32 v28, v28, v29
    v_mov_b32 v30, v28
    s_nop 1
    v_permlane32_swap_b32 v28, v30
    v_max_f32 v28, v28, v30
    v_max_f32 v28, 0, v28
    v_ceil_f32 v28, v28
    v_sub_f32 v29, 0, v28
    v_exp_f32 v29, v29
    v_sub_f32 v64, v64, v28
    v_sub_f32 v96, v96, v28
    v_sub_f32 v65, v65, v28
    v_sub_f32 v97, v97, v28
    v_sub_f32 v66, v66, v28
    v_sub_f32 v98, v98, v28
    v_sub_f32 v67, v67, v28
    v_sub_f32 v99, v99, v28
    v_sub_f32 v68, v68, v28
    v_sub_f32 v100, v100, v28
    v_sub_f32 v69, v69, v28
    v_sub_f32 v101, v101, v28
    v_sub_f32 v70, v70, v28
    v_sub_f32 v102, v102, v28
    v_sub_f32 v71, v71, v28
    v_sub_f32 v103, v103, v28
    v_sub_f32 v72, v72, v28
    v_sub_f32 v104, v104, v28
    v_sub_f32 v73, v73, v28
    v_sub_f32 v105, v105, v28
    v_sub_f32 v74, v74, v28
    v_sub_f32 v106, v106, v28
    v_sub_f32 v75, v75, v28
    v_sub_f32 v107, v107, v28
    v_sub_f32 v76, v76, v28
    v_sub_f32 v108, v108, v28
    v_sub_f32 v77, v77, v28
    v_sub_f32 v109, v109, v28
    v_sub_f32 v78, v78, v28
    v_sub_f32 v110, v110, v28
    v_sub_f32 v79, v79, v28
    v_sub_f32 v111, v111, v28
    v_mul_f32 v192, v29, v192
    v_mul_f32 v193, v29, v193
    v_mul_f32 v194, v29, v194
    v_mul_f32 v195, v29, v195
    v_mul_f32 v196, v29, v196
    v_mul_f32 v197, v29, v197
    v_mul_f32 v198, v29, v198
    v_mul_f32 v199, v29, v199
    v_mul_f32 v200, v29, v200
    v_mul_f32 v201, v29, v201
    v_mul_f32 v202, v29, v202
    v_mul_f32 v203, v29, v203
    v_mul_f32 v204, v29, v204
    v_mul_f32 v205, v29, v205
    v_mul_f32 v206, v29, v206
    v_mul_f32 v207, v29, v207
    v_mul_f32 v208, v29, v208
    v_mul_f32 v209, v29, v209
    v_mul_f32 v210, v29, v210
    v_mul_f32 v211, v29, v211
    v_mul_f32 v212, v29, v212
    v_mul_f32 v213, v29, v213
    v_mul_f32 v214, v29, v214
    v_mul_f32 v215, v29, v215
    v_mul_f32 v216, v29, v216
    v_mul_f32 v217, v29, v217
    v_mul_f32 v218, v29, v218
    v_mul_f32 v219, v29, v219
    v_mul_f32 v220, v29, v220
    v_mul_f32 v221, v29, v221
    v_mul_f32 v222, v29, v222
    v_mul_f32 v223, v29, v223
    v_mul_f32 v224, v29, v224
    v_mul_f32 v225, v29, v225
    v_mul_f32 v226, v29, v226
    v_mul_f32 v227, v29, v227
    v_mul_f32 v228, v29, v228
    v_mul_f32 v229, v29, v229
    v_mul_f32 v230, v29, v230
    v_mul_f32 v231, v29, v231
    v_mul_f32 v232, v29, v232
    v_mul_f32 v233, v29, v233
    v_mul_f32 v234, v29, v234
    v_mul_f32 v235, v29, v235
    v_mul_f32 v236, v29, v236
    v_mul_f32 v237, v29, v237
    v_mul_f32 v238, v29, v238
    v_mul_f32 v239, v29, v239
    v_mul_f32 v240, v29, v240
    v_mul_f32 v241, v29, v241
    v_mul_f32 v242, v29, v242
    v_mul_f32 v243, v29, v243
    v_mul_f32 v244, v29, v244
    v_mul_f32 v245, v29, v245
    v_mul_f32 v246, v29, v246
    v_mul_f32 v247, v29, v247
    v_mul_f32 v248, v29, v248
    v_mul_f32 v249, v29, v249
    v_mul_f32 v250, v29, v250
    v_mul_f32 v251, v29, v251
    v_mul_f32 v252, v29, v252
    v_mul_f32 v253, v29, v253
    v_mul_f32 v254, v29, v254
    v_mul_f32 v255, v29, v255
    v_mul_f32 v14, v29, v14
    v_exp_f32 v122, v64
    v_exp_f32 v123, v65
    v_exp_f32 v124, v66
    v_exp_f32 v125, v67
    v_add_f32 v15, v122, v123
    v_cvt_pk_bf16_f32 v112, v122, v123
    v_exp_f32 v126, v68
    v_exp_f32 v127, v69
    v_add_f32 v28, v124, v125
    v_cvt_pk_bf16_f32 v113, v124, v125
    v_exp_f32 v122, v70
    v_exp_f32 v123, v71
    v_add_f32 v15, v15, v126
    v_add_f32 v28, v28, v127
    v_cvt_pk_bf16_f32 v114, v126, v127
    v_exp_f32 v124, v72
    v_exp_f32 v125, v73
    v_add_f32 v15, v15, v122
    v_add_f32 v28, v28, v123
    v_cvt_pk_bf16_f32 v115, v122, v123
    v_exp_f32 v126, v74
    v_exp_f32 v127, v75
    v_add_f32 v15, v15, v124
    v_add_f32 v28, v28, v125
    v_cvt_pk_bf16_f32 v116, v124, v125
    v_exp_f32 v122, v76
    v_exp_f32 v123, v77
    v_add_f32 v15, v15, v126
    v_add_f32 v28, v28, v127
    v_cvt_pk_bf16_f32 v117, v126, v127
    v_exp_f32 v124, v78
    v_exp_f32 v125, v79
    v_add_f32 v15, v15, v122
    v_add_f32 v28, v28, v123
    v_cvt_pk_bf16_f32 v118, v122, v123
    v_add_f32 v15, v15, v124
    v_add_f32 v28, v28, v125
    v_cvt_pk_bf16_f32 v119, v124, v125
    v_add_f32 v15, v15, v28
    s_nop 1
    s_setpc_b64 s[40:41]
F_rarehf:
    s_nop 15
    v_max3_f32 v28, v64, v65, v66
    v_max3_f32 v29, v67, v68, v69
    v_max3_f32 v28, v28, v70, v71
    v_max3_f32 v29, v29, v72, v73
    v_max3_f32 v28, v28, v74, v75
    v_max3_f32 v29, v29, v76, v77
    v_max3_f32 v28, v28, v78, v79
    v_max_f32 v28, v28, v29
    v_mov_b32 v30, v28
    s_nop 1
    v_permlane32_swap_b32 v28, v30
    v_max_f32 v28, v28, v30
    v_ceil_f32 v28, v28
    v_sub_f32 v64, v64, v28
    v_sub_f32 v96, v96, v28
    v_sub_f32 v65, v65, v28
    v_sub_f32 v97, v97, v28
    v_sub_f32 v66, v66, v28
    v_sub_f32 v98, v98, v28
    v_sub_f32 v67, v67, v28
    v_sub_f32 v99, v99, v28
    v_sub_f32 v68, v68, v28
    v_sub_f32 v100, v100, v28
    v_sub_f32 v69, v69, v28
    v_sub_f32 v101, v101, v28
    v_sub_f32 v70, v70, v28
    v_sub_f32 v102, v102, v28
    v_sub_f32 v71, v71, v28
    v_sub_f32 v103, v103, v28
    v_sub_f32 v72, v72, v28
    v_sub_f32 v104, v104, v28
    v_sub_f32 v73, v73, v28
    v_sub_f32 v105, v105, v28
    v_sub_f32 v74, v74, v28
    v_sub_f32 v106, v106, v28
    v_sub_f32 v75, v75, v28
    v_sub_f32 v107, v107, v28
    v_sub_f32 v76, v76, v28
    v_sub_f32 v108, v108, v28
    v_sub_f32 v77, v77, v28
    v_sub_f32 v109, v109, v28
    v_sub_f32 v78, v78, v28
    v_sub_f32 v110, v110, v28
    v_sub_f32 v79, v79, v28
    v_sub_f32 v111, v111, v28
    v_exp_f32 v122, v64
    v_exp_f32 v123, v65
    v_exp_f32 v124, v66
    v_exp_f32 v125, v67
    v_add_f32 v15, v122, v123
    v_cvt_pk_bf16_f32 v112, v122, v123
    v_exp_f32 v126, v68
    v_exp_f32 v127, v69
    v_add_f32 v28, v124, v125
    v_cvt_pk_bf16_f32 v113, v124, v125
    v_exp_f32 v122, v70
    v_exp_f32 v123, v71
    v_add_f32 v15, v15, v126
    v_add_f32 v28, v28, v127
    v_cvt_pk_bf16_f32 v114, v126, v127
    v_exp_f32 v124, v72
    v_exp_f32 v125, v73
    v_add_f32 v15, v15, v122
    v_add_f32 v28, v28, v123
    v_cvt_pk_bf16_f32 v115, v122, v123
    v_exp_f32 v126, v74
    v_exp_f32 v127, v75
    v_add_f32 v15, v15, v124
    v_add_f32 v28, v28, v125
    v_cvt_pk_bf16_f32 v116, v124, v125
    v_exp_f32 v122, v76
    v_exp_f32 v123, v77
    v_add_f32 v15, v15, v126
    v_add_f32 v28, v28, v127
    v_cvt_pk_bf16_f32 v117, v126, v127
    v_exp_f32 v124, v78
    v_exp_f32 v125, v79
    v_add_f32 v15, v15, v122
    v_add_f32 v28, v28, v123
    v_cvt_pk_bf16_f32 v118, v122, v123
    v_add_f32 v15, v15, v124
    v_add_f32 v28, v28, v125
    v_cvt_pk_bf16_f32 v119, v124, v125
    v_add_f32 v15, v15, v28
    s_nop 1
    s_setpc_b64 s[40:41]
F_last:
    s_endpgm
.section .rodata,"a"
.p2align 6
.amdhsa_kernel standalone__mha_block_cached__near_ridge_kernel
  .amdhsa_next_free_vgpr 256
  .amdhsa_next_free_sgpr 102
  .amdhsa_accum_offset 256
  .amdhsa_group_segment_fixed_size 0
  .amdhsa_kernarg_size 64
  .amdhsa_user_sgpr_count 2
  .amdhsa_user_sgpr_kernarg_segment_ptr 1
  .amdhsa_system_sgpr_workgroup_id_x 1
.end_amdhsa_kernel
```
